```python
import torch

def _softmax(x, axis=-1):
    return torch.softmax(x, dim=axis)
def _gelu(x):
    return torch.nn.functional.gelu(x, approximate="tanh")
def _silu(x):
    return torch.nn.functional.silu(x)
def _sigmoid(x):
    return torch.sigmoid(x)
def _layernorm(x, axis=-1, eps=1e-5):
    m = x.mean(dim=axis, keepdim=True)
    v = x.var(dim=axis, keepdim=True, unbiased=False)
    return (x - m) / torch.sqrt(v + eps)
def _scatter_add(tgt, idx, src, axis=0):
    return tgt.clone().index_add_(axis, idx, src)
def _segment_sum(src, seg, n):
    out = torch.zeros((n,) + src.shape[1:], dtype=src.dtype)
    return out.index_add_(0, seg, src)
def _pad(x, pw):
    flat = tuple(v for pair in reversed(pw) for v in pair)
    return torch.nn.functional.pad(x, flat)

kernel_name = 'gather_scatter__edge_featured_mpnn_mpnn__graph'

def setup_inputs():

    _w = (lambda a: (lambda t: t.to(torch.bfloat16) if t.is_floating_point() else t)(torch.as_tensor(a)))
    N, deg, D, De = 10000, 64, 64, max(0, 1)
    E = N * deg
    H = 2 * D
    return {
        "x": _w((lambda *s: torch.randn(*s, dtype=torch.bfloat16) * 0.05)(N, D)),
        "e_attr": _w((lambda *s: torch.randn(*s, dtype=torch.bfloat16) * 1.6)(E, De)),
        "src": _w((lambda lo, hi, *s: torch.randint(lo, hi, s))(0, N, E).to(torch.int64)),
        "dst": _w((lambda lo, hi, *s: torch.randint(lo, hi, s))(0, N, E).to(torch.int64)),
        "w1": _w((lambda *s: torch.randn(*s, dtype=torch.bfloat16) * 1.6)(2 * D + De, H) * (1.0 / (2 * D + De) ** 0.5)),
        "b1": _w((lambda *s: torch.randn(*s, dtype=torch.bfloat16) * 3.2)(H) * 0.01),
        "w2": _w((lambda *s: torch.randn(*s, dtype=torch.bfloat16) * 0.05)(H, D) * (1.0 / H ** 0.5)),
        "b2": _w((lambda *s: torch.randn(*s, dtype=torch.bfloat16) * 0.1)(D) * 0.01),
    }

def reference(x, e_attr, src, dst, w1, b1, w2, b2):
    N, D = x.shape
    h_src = x[src]
    h_dst = x[dst]
    m_in = torch.concatenate([h_src, h_dst, e_attr], axis=-1)
    h = _silu(m_in @ w1 + b1)
    msg = h @ w2 + b2
    return _segment_sum(msg, dst, N)
```

```asm
; @launch kernel=mpnn_bin_kernel grid=(261,1,1) block=(640,1,1) lds=47104
; @launch kernel=mpnn_main_kernel grid=(256,1,1) block=(512,1,1) lds=163712
.amdgcn_target "amdgcn-amd-amdhsa--gfx950"
.text
.globl mpnn_bin_kernel
.p2align 8
.type mpnn_bin_kernel,@function
mpnn_bin_kernel:
    s_cmp_ge_u32 s2, 261
    s_cbranch_scc1 K1_END
    s_load_dwordx2 s[4:5], s[0:1], 80
    s_cmp_ge_u32 s2, 256
    s_cbranch_scc1 K1_PREP
    s_load_dwordx2 s[6:7], s[0:1], 8
    s_load_dwordx4 s[8:11], s[0:1], 16
    v_lshlrev_b32 v1, 4, v0
    v_lshlrev_b32 v2, 3, v0
    s_movk_i32 s40, 144
    v_mov_b32 v3, 0
    v_lshlrev_b32 v4, 2, v0
    v_cmp_gt_u32 vcc, 256, v0
    s_and_saveexec_b64 s[30:31], vcc
    ds_write_b32 v4, v3
    s_mov_b64 exec, s[30:31]
    s_movk_i32 s3, 625
    v_cmp_gt_u32 s[28:29], s3, v0
    s_mul_i32 s32, s2, 10000
    s_mul_i32 s33, s2, 5000
    s_waitcnt lgkmcnt(0)
    s_mov_b32 s12, s10
    s_mov_b32 s13, s11
    s_mov_b32 s14, 0x271000
    s_mov_b32 s15, 0x00020000
    s_mov_b32 s16, s8
    s_mov_b32 s17, s9
    s_mov_b32 s18, 0x271000
    s_mov_b32 s19, 0x00020000
    s_mov_b32 s20, s6
    s_mov_b32 s21, s7
    s_mov_b32 s22, 0x138800
    s_mov_b32 s23, 0x00020000
    s_mov_b32 s24, s4
    s_mov_b32 s25, s5
    s_mov_b32 s26, 0x1550000
    s_mov_b32 s27, 0x00020000
    s_mov_b64 exec, s[28:29]
    buffer_load_dwordx4 v[8:11], v1, s[12:15], s32 offen
    buffer_load_dwordx4 v[12:15], v1, s[16:19], s32 offen
    buffer_load_dwordx2 v[16:17], v2, s[20:23], s33 offen
    s_mov_b64 exec, -1
    s_mov_b32 s35, 429497
    s_movk_i32 s36, 625
    v_mov_b32 v5, 1
    v_lshrrev_b32 v50, 3, v0
    v_and_b32 v51, 7, v0
    v_lshlrev_b32 v51, 4, v51
    v_mad_u32_u24 v52, v50, s40, v51
    v_and_b32 v54, 7, v0
    v_lshl_add_u32 v53, v50, 15, v51
    v_lshlrev_b32 v50, 2, v50
    s_lshl_b32 s34, s2, 7
    s_mov_b64 exec, s[28:29]
    s_barrier
    s_waitcnt vmcnt(2)
    v_mul_u32_u24 v20, s35, v8
    v_lshrrev_b32 v20, 24, v20
    v_lshlrev_b32 v24, 2, v20
    ds_add_rtn_u32 v28, v24, v5
    v_mul_u32_u24 v21, s35, v9
    v_lshrrev_b32 v21, 24, v21
    v_lshlrev_b32 v25, 2, v21
    ds_add_rtn_u32 v29, v25, v5
    v_mul_u32_u24 v22, s35, v10
    v_lshrrev_b32 v22, 24, v22
    v_lshlrev_b32 v26, 2, v22
    ds_add_rtn_u32 v30, v26, v5
    v_mul_u32_u24 v23, s35, v11
    v_lshrrev_b32 v23, 24, v23
    v_lshlrev_b32 v27, 2, v23
    ds_add_rtn_u32 v31, v27, v5
    v_mul_u32_u24 v44, s40, v20
    v_mad_u32_u24 v20, v20, s36, 15
    v_lshrrev_b32 v20, 4, v20
    v_sub_u32 v20, v8, v20
    v_lshlrev_b32 v33, 2, v20
    v_mul_u32_u24 v45, s40, v21
    v_mad_u32_u24 v21, v21, s36, 15
    v_lshrrev_b32 v21, 4, v21
    v_sub_u32 v21, v9, v21
    v_lshlrev_b32 v35, 2, v21
    v_mul_u32_u24 v46, s40, v22
    v_mad_u32_u24 v22, v22, s36, 15
    v_lshrrev_b32 v22, 4, v22
    v_sub_u32 v22, v10, v22
    v_lshlrev_b32 v37, 2, v22
    v_mul_u32_u24 v47, s40, v23
    v_mad_u32_u24 v23, v23, s36, 15
    v_lshrrev_b32 v23, 4, v23
    v_sub_u32 v23, v11, v23
    v_lshlrev_b32 v39, 2, v23
    s_waitcnt vmcnt(0)
    s_mov_b32 s37, 0xffff0000
    v_lshl_or_b32 v32, v16, 16, v12
    v_and_or_b32 v34, v16, s37, v13
    v_lshl_or_b32 v36, v17, 16, v14
    v_and_or_b32 v38, v17, s37, v15
    s_waitcnt lgkmcnt(0)
    v_and_b32 v8, 7, v28
    v_lshrrev_b32 v9, 3, v28
    v_cmp_gt_u32 vcc, 24, v28
    v_lshl_add_u32 v8, v8, 4, v44
    v_lshl_add_u32 v10, v9, 2, v8
    v_add_u32 v12, v9, v8
    s_and_b64 exec, s[28:29], vcc
    ds_write_b32 v10, v32 offset:1024
    ds_write_b8 v12, v33 offset:1036
    s_mov_b64 exec, s[28:29]
    v_and_b32 v8, 7, v29
    v_lshrrev_b32 v9, 3, v29
    v_cmp_gt_u32 vcc, 24, v29
    v_lshl_add_u32 v8, v8, 4, v45
    v_lshl_add_u32 v11, v9, 2, v8
    v_add_u32 v13, v9, v8
    s_and_b64 exec, s[28:29], vcc
    ds_write_b32 v11, v34 offset:1024
    ds_write_b8 v13, v35 offset:1036
    s_mov_b64 exec, s[28:29]
    v_and_b32 v8, 7, v30
    v_lshrrev_b32 v9, 3, v30
    v_cmp_gt_u32 vcc, 24, v30
    v_lshl_add_u32 v8, v8, 4, v46
    v_lshl_add_u32 v10, v9, 2, v8
    v_add_u32 v12, v9, v8
    s_and_b64 exec, s[28:29], vcc
    ds_write_b32 v10, v36 offset:1024
    ds_write_b8 v12, v37 offset:1036
    s_mov_b64 exec, s[28:29]
    v_and_b32 v8, 7, v31
    v_lshrrev_b32 v9, 3, v31
    v_cmp_gt_u32 vcc, 24, v31
    v_lshl_add_u32 v8, v8, 4, v47
    v_lshl_add_u32 v11, v9, 2, v8
    v_add_u32 v13, v9, v8
    s_and_b64 exec, s[28:29], vcc
    ds_write_b32 v11, v38 offset:1024
    ds_write_b8 v13, v39 offset:1036
    s_mov_b64 exec, s[28:29]
    v_max3_u32 v8, v28, v29, v30
    v_max_u32 v8, v8, v31
    v_cmp_le_u32 vcc, 24, v8
    s_cbranch_vccnz K1_B
K1_NOB:
    s_mov_b64 exec, -1
    v_and_b32 v6, 63, v0
    v_lshlrev_b32 v6, 4, v6
    s_movk_i32 s50, 128
    v_cmp_gt_u32 s[44:45], s50, v0
    s_waitcnt lgkmcnt(0)
    s_barrier
    ds_read_b32 v20, v50 offset:0
    ds_read_b128 v[56:59], v52 offset:1024
    ds_read_b32 v21, v50 offset:320
    ds_read_b128 v[60:63], v52 offset:12544
    ds_read_b32 v22, v50 offset:640
    ds_read_b128 v[64:67], v52 offset:24064
    s_or_b64 exec, s[44:45], 1
    ds_read_b32 v23, v50 offset:960
    ds_read_b128 v[68:71], v52 offset:35584
    s_mov_b64 exec, -1
    ds_read_b128 v[40:43], v6
    ds_read_b32 v7, v4
    s_waitcnt lgkmcnt(8)
    v_cmp_lt_u32 vcc, v54, v20
    s_mov_b64 exec, vcc
    buffer_store_dwordx4 v[56:59], v53, s[24:27], s34 offen
    s_mov_b64 exec, -1
    s_add_u32 s34, s34, 2621440
    s_waitcnt lgkmcnt(6)
    v_cmp_lt_u32 vcc, v54, v21
    s_mov_b64 exec, vcc
    buffer_store_dwordx4 v[60:63], v53, s[24:27], s34 offen
    s_mov_b64 exec, -1
    s_add_u32 s34, s34, 2621440
    s_waitcnt lgkmcnt(4)
    v_cmp_lt_u32 vcc, v54, v22
    s_mov_b64 exec, vcc
    buffer_store_dwordx4 v[64:67], v53, s[24:27], s34 offen
    s_mov_b64 exec, -1
    s_add_u32 s34, s34, 2621440
    s_waitcnt lgkmcnt(2)
    v_cmp_lt_u32 vcc, v54, v23
    s_and_b64 vcc, vcc, s[44:45]
    s_mov_b64 exec, vcc
    buffer_store_dwordx4 v[68:71], v53, s[24:27], s34 offen
    s_mov_b64 exec, -1
    s_add_u32 s34, s34, 2621440
    s_lshl_b32 s41, s2, 8
    s_add_u32 s41, s41, 0x1100000
    v_cmp_gt_u32 vcc, 256, v0
    s_waitcnt lgkmcnt(0)
    v_min_u32 v7, 0xff, v7
    s_mov_b64 exec, vcc
    buffer_store_byte v7, v0, s[24:27], s41 offen
    s_mov_b64 exec, -1
    s_waitcnt lgkmcnt(0)
    v_max3_u32 v7, v40, v41, v42
    v_max_u32 v7, v7, v43
    v_cmp_lt_u32 vcc, 32, v7
    s_cbranch_vccnz K1_SLOW
    s_endpgm
K1_SLOW:
    s_barrier
    v_add_u32 v45, v40, v41
    v_add_u32 v46, v45, v42
    v_add_u32 v47, v46, v43
    v_mov_b32 v48, v47
    s_nop 1
    v_add_u32_dpp v48, v48, v48 row_shr:1 row_mask:0xf bank_mask:0xf bound_ctrl:0
    s_nop 1
    v_add_u32_dpp v48, v48, v48 row_shr:2 row_mask:0xf bank_mask:0xf bound_ctrl:0
    s_nop 1
    v_add_u32_dpp v48, v48, v48 row_shr:4 row_mask:0xf bank_mask:0xf bound_ctrl:0
    s_nop 1
    v_add_u32_dpp v48, v48, v48 row_shr:8 row_mask:0xf bank_mask:0xf bound_ctrl:0
    s_nop 1
    v_add_u32_dpp v48, v48, v48 row_bcast:15 row_mask:0xa bank_mask:0xf
    s_nop 1
    v_add_u32_dpp v48, v48, v48 row_bcast:31 row_mask:0xc bank_mask:0xf
    v_sub_u32 v44, v48, v47
    v_add_u32 v47, v46, v44
    v_add_u32 v46, v45, v44
    v_add_u32 v45, v40, v44
    ds_write_b128 v6, v[44:47] offset:1024
    s_mov_b64 exec, s[28:29]
    ds_read_b32 v20, v24 offset:1024
    ds_read_b32 v21, v25 offset:1024
    ds_read_b32 v22, v26 offset:1024
    ds_read_b32 v23, v27 offset:1024
    s_lshl_b32 s38, s2, 10
    s_add_u32 s38, s38, 0x1500000
    v_cmp_gt_u32 vcc, 64, v0
    s_cbranch_vccz K1_NOOFF
    v_lshl_or_b32 v44, v40, 16, v44
    v_lshl_or_b32 v45, v41, 16, v45
    v_lshl_or_b32 v46, v42, 16, v46
    v_lshl_or_b32 v47, v43, 16, v47
    buffer_store_dwordx4 v[44:47], v6, s[24:27], s38 offen
K1_NOOFF:
    s_waitcnt lgkmcnt(0)
    v_add_lshl_u32 v20, v20, v28, 3
    ds_write_b64 v20, v[32:33] offset:2048
    v_add_lshl_u32 v21, v21, v29, 3
    ds_write_b64 v21, v[34:35] offset:2048
    v_add_lshl_u32 v22, v22, v30, 3
    ds_write_b64 v22, v[36:37] offset:2048
    v_add_lshl_u32 v23, v23, v31, 3
    ds_write_b64 v23, v[38:39] offset:2048
    s_waitcnt lgkmcnt(0)
    s_barrier
    ds_read_b128 v[8:11], v1 offset:2048
    ds_read_b128 v[12:15], v1 offset:12048
    s_mul_i32 s34, s2, 20000
    s_add_u32 s34, s34, 0x800000
    s_add_u32 s39, s34, 10000
    s_waitcnt lgkmcnt(1)
    buffer_store_dwordx4 v[8:11], v1, s[24:27], s34 offen
    s_waitcnt lgkmcnt(0)
    buffer_store_dwordx4 v[12:15], v1, s[24:27], s39 offen
    s_endpgm
K1_B:
    s_lshl_b32 s41, s2, 6
    s_add_u32 s41, s41, 0xcfff40
    v_lshrrev_b32 v9, 3, v28
    v_lshlrev_b32 v8, 12, v24
    v_cmp_eq_u32 vcc, 3, v9
    v_lshl_add_u32 v8, v28, 3, v8
    s_and_b64 exec, s[28:29], vcc
    buffer_store_dwordx2 v[32:33], v8, s[24:27], s41 offen
    s_mov_b64 exec, s[28:29]
    v_lshrrev_b32 v9, 3, v29
    v_lshlrev_b32 v8, 12, v25
    v_cmp_eq_u32 vcc, 3, v9
    v_lshl_add_u32 v8, v29, 3, v8
    s_and_b64 exec, s[28:29], vcc
    buffer_store_dwordx2 v[34:35], v8, s[24:27], s41 offen
    s_mov_b64 exec, s[28:29]
    v_lshrrev_b32 v9, 3, v30
    v_lshlrev_b32 v8, 12, v26
    v_cmp_eq_u32 vcc, 3, v9
    v_lshl_add_u32 v8, v30, 3, v8
    s_and_b64 exec, s[28:29], vcc
    buffer_store_dwordx2 v[36:37], v8, s[24:27], s41 offen
    s_mov_b64 exec, s[28:29]
    v_lshrrev_b32 v9, 3, v31
    v_lshlrev_b32 v8, 12, v27
    v_cmp_eq_u32 vcc, 3, v9
    v_lshl_add_u32 v8, v31, 3, v8
    s_and_b64 exec, s[28:29], vcc
    buffer_store_dwordx2 v[38:39], v8, s[24:27], s41 offen
    s_mov_b64 exec, s[28:29]
    s_branch K1_NOB
K1_PREP:
    s_load_dwordx8 s[8:15], s[0:1], 32
    v_lshrrev_b32 v1, 6, v0
    s_nop 0
    v_readfirstlane_b32 s3, v1
    s_sub_u32 s32, s2, 256
    s_mul_i32 s32, s32, 10
    s_add_u32 s3, s3, s32
    v_and_b32 v1, 63, v0
    s_waitcnt lgkmcnt(0)
    s_mov_b32 s16, s8
    s_mov_b32 s17, s9
    s_mov_b32 s18, 0x8100
    s_mov_b32 s19, 0x00020000
    s_mov_b32 s20, s12
    s_mov_b32 s21, s13
    s_mov_b32 s22, 0x4000
    s_mov_b32 s23, 0x00020000
    s_mov_b32 s24, s4
    s_mov_b32 s25, s5
    s_mov_b32 s26, 0x1550000
    s_mov_b32 s27, 0x00020000
    s_mov_b32 s40, s10
    s_mov_b32 s41, s11
    s_mov_b32 s42, 0x100
    s_mov_b32 s43, 0x00020000
    s_mov_b32 s44, s14
    s_mov_b32 s45, s15
    s_mov_b32 s46, 0x80
    s_mov_b32 s47, 0x00020000
    s_mov_b32 s36, 0xbfb8aa3b
    s_cmp_ge_u32 s3, 48
    s_cbranch_scc1 K1_MISC
    s_lshl_b32 s33, s3, 10
    s_add_u32 s33, s33, 0x1540000
    s_cmp_ge_u32 s3, 16
    s_cselect_b32 s34, 2048, 0
    s_add_u32 s33, s33, s34
    v_lshlrev_b32 v2, 4, v1
    s_and_b32 s34, s3, 3
    s_bfe_u32 s35, s3, 0x20002
    s_cmp_ge_u32 s3, 16
    s_cbranch_scc1 K1_W2
    v_lshrrev_b32 v3, 5, v1
    v_lshlrev_b32 v3, 11, v3
    v_and_b32 v4, 31, v1
    v_lshl_add_u32 v3, v4, 1, v3
    s_lshl_b32 s37, s34, 12
    s_lshl_b32 s38, s35, 6
    s_add_u32 s37, s37, s38
    buffer_load_ushort v8, v3, s[16:19], s37 offen offset:0
    buffer_load_ushort v9, v3, s[16:19], s37 offen offset:256
    buffer_load_ushort v10, v3, s[16:19], s37 offen offset:512
    buffer_load_ushort v11, v3, s[16:19], s37 offen offset:768
    buffer_load_ushort v12, v3, s[16:19], s37 offen offset:1024
    buffer_load_ushort v13, v3, s[16:19], s37 offen offset:1280
    buffer_load_ushort v14, v3, s[16:19], s37 offen offset:1536
    buffer_load_ushort v15, v3, s[16:19], s37 offen offset:1792
    s_waitcnt vmcnt(0)
    v_lshlrev_b32 v8, 16, v8
    v_mul_f32 v8, s36, v8
    v_lshlrev_b32 v9, 16, v9
    v_mul_f32 v9, s36, v9
    v_lshlrev_b32 v10, 16, v10
    v_mul_f32 v10, s36, v10
    v_lshlrev_b32 v11, 16, v11
    v_mul_f32 v11, s36, v11
    v_lshlrev_b32 v12, 16, v12
    v_mul_f32 v12, s36, v12
    v_lshlrev_b32 v13, 16, v13
    v_mul_f32 v13, s36, v13
    v_lshlrev_b32 v14, 16, v14
    v_mul_f32 v14, s36, v14
    v_lshlrev_b32 v15, 16, v15
    v_mul_f32 v15, s36, v15
    v_cvt_pk_bf16_f32 v16, v8, v9
    v_cvt_pk_bf16_f32 v17, v10, v11
    v_cvt_pk_bf16_f32 v18, v12, v13
    v_cvt_pk_bf16_f32 v19, v14, v15
    buffer_store_dwordx4 v[16:19], v2, s[24:27], s33 offen
    s_endpgm
K1_W2:
    v_lshrrev_b32 v3, 4, v1
    v_and_b32 v4, 15, v1
    s_cmp_ge_u32 s3, 32
    s_cbranch_scc1 K1_W2B
    v_lshlrev_b32 v3, 11, v3
    v_lshl_add_u32 v3, v4, 1, v3
    s_and_b32 s37, s3, 1
    s_lshl_b32 s37, s37, 13
    s_bfe_u32 s38, s3, 0x30001
    s_lshl_b32 s38, s38, 5
    s_add_u32 s37, s37, s38
    s_add_u32 s37, s37, 16384
    buffer_load_ushort v8, v3, s[16:19], s37 offen offset:0
    buffer_load_ushort v9, v3, s[16:19], s37 offen offset:256
    buffer_load_ushort v10, v3, s[16:19], s37 offen offset:512
    buffer_load_ushort v11, v3, s[16:19], s37 offen offset:768
    buffer_load_ushort v12, v3, s[16:19], s37 offen offset:1024
    buffer_load_ushort v13, v3, s[16:19], s37 offen offset:1280
    buffer_load_ushort v14, v3, s[16:19], s37 offen offset:1536
    buffer_load_ushort v15, v3, s[16:19], s37 offen offset:1792
    s_branch K1_PACK
K1_W2B:
    v_lshlrev_b32 v3, 10, v3
    v_lshl_add_u32 v3, v4, 1, v3
    s_lshl_b32 s37, s34, 12
    s_lshl_b32 s38, s35, 5
    s_add_u32 s37, s37, s38
    buffer_load_ushort v8, v3, s[20:23], s37 offen offset:0
    buffer_load_ushort v9, v3, s[20:23], s37 offen offset:128
    buffer_load_ushort v10, v3, s[20:23], s37 offen offset:256
    buffer_load_ushort v11, v3, s[20:23], s37 offen offset:384
    buffer_load_ushort v12, v3, s[20:23], s37 offen offset:512
    buffer_load_ushort v13, v3, s[20:23], s37 offen offset:640
    buffer_load_ushort v14, v3, s[20:23], s37 offen offset:768
    buffer_load_ushort v15, v3, s[20:23], s37 offen offset:896
K1_PACK:
    s_waitcnt vmcnt(0)
    v_lshl_or_b32 v16, v9, 16, v8
    v_lshl_or_b32 v17, v11, 16, v10
    v_lshl_or_b32 v18, v13, 16, v12
    v_lshl_or_b32 v19, v15, 16, v14
    buffer_store_dwordx4 v[16:19], v2, s[24:27], s33 offen
    s_endpgm
K1_MISC:
    s_sub_u32 s33, s3, 48
    s_lshl_b32 s33, s33, 6
    v_add_u32 v2, s33, v1
    v_lshlrev_b32 v3, 1, v2
    s_mov_b32 s37, 32768
    buffer_load_ushort v8, v3, s[16:19], s37 offen offset:0
    buffer_load_ushort v9, v3, s[40:43], 0 offen
    buffer_load_ushort v10, v3, s[44:47], 0 offen
    v_lshrrev_b32 v4, 5, v2
    v_lshlrev_b32 v4, 8, v4
    v_and_b32 v5, 31, v2
    v_lshl_add_u32 v4, v5, 2, v4
    v_lshlrev_b32 v5, 2, v2
    s_waitcnt vmcnt(0)
    v_lshlrev_b32 v8, 16, v8
    v_mul_f32 v8, s36, v8
    v_cvt_pk_bf16_f32 v11, v8, v8
    v_lshlrev_b32 v11, 16, v11
    v_sub_f32 v12, v8, v11
    v_cvt_pk_bf16_f32 v12, v12, v12
    v_lshlrev_b32 v12, 16, v12
    v_lshlrev_b32 v9, 16, v9
    v_mul_f32 v9, s36, v9
    v_lshlrev_b32 v10, 16, v10
    s_mov_b32 s38, 0x1544000
    buffer_store_dword v11, v4, s[24:27], s38 offen
    buffer_store_dword v12, v4, s[24:27], s38 offen offset:128
    buffer_store_dword v9, v5, s[24:27], s38 offen offset:1024
    buffer_store_dword v10, v5, s[24:27], s38 offen offset:1536
K1_END:
    s_endpgm
.globl mpnn_main_kernel
.p2align 8
.type mpnn_main_kernel,@function
mpnn_main_kernel:
    s_cmp_ge_u32 s2, 256
    s_cbranch_scc1 K2_END
    s_load_dwordx2 s[6:7], s[0:1], 80
    s_load_dwordx2 s[4:5], s[0:1], 0
    s_load_dwordx2 s[8:9], s[0:1], 64
    v_lshrrev_b32 v216, 6, v0
    v_and_b32 v1, 63, v0
    v_readfirstlane_b32 s24, v216
    s_and_b32 s3, s2, 7
    s_lshl_b32 s3, s3, 5
    s_lshr_b32 s25, s2, 3
    s_or_b32 s3, s3, s25
    s_mul_i32 s25, s3, 625
    s_add_u32 s26, s25, 640
    s_add_u32 s25, s25, 15
    s_lshr_b32 s25, s25, 4
    s_lshr_b32 s26, s26, 4
    s_sub_u32 s26, s26, s25
    s_mov_b32 s27, 0
    s_mov_b32 s35, 0
    s_mov_b32 s28, 0
    s_movk_i32 s82, 0x4000
    s_mov_b32 s83, 0xffff
    v_lshlrev_b32 v5, 4, v1
    v_lshlrev_b32 v4, 3, v1
    v_and_b32 v224, 31, v1
    v_lshlrev_b32 v224, 2, v224
    v_add_u32 v2, 0x1e490, v224
    v_add_u32 v3, 0x14e00, v224
    s_lshl_b32 s36, s24, 12
    s_add_u32 s36, s36, 0x4200
    s_lshl_b32 s37, s24, 12
    s_add_u32 s37, s37, 0x4600
    s_lshl_b32 s38, s24, 12
    s_add_u32 s38, s38, 0x4a00
    s_lshl_b32 s39, s24, 12
    s_add_u32 s39, s39, 0x4e00
    s_waitcnt lgkmcnt(0)
    s_mov_b32 s16, s6
    s_mov_b32 s17, s7
    s_mov_b32 s18, 0x1550000
    s_mov_b32 s19, 0x00020000
    s_mov_b32 s12, s4
    s_and_b32 s13, s5, 0xffff
    s_or_b32 s13, s13, 0x00800000
    s_mov_b32 s14, 10000
    s_mov_b32 s15, 0x00020000
    s_mov_b32 s20, s8
    s_mov_b32 s21, s9
    s_mov_b32 s22, 0x138800
    s_mov_b32 s23, 0x00020000
K2_RESTART:
    v_mov_b32 v196, 0
    v_mov_b32 v197, 0
    v_mov_b32 v198, 0
    v_mov_b32 v199, 0
    v_mov_b32 v200, 0
    v_mov_b32 v201, 0
    v_mov_b32 v202, 0
    v_mov_b32 v203, 0
    v_mov_b32 v204, 0
    v_mov_b32 v205, 0
    v_mov_b32 v206, 0
    v_mov_b32 v207, 0
    v_mov_b32 v208, 0
    v_mov_b32 v209, 0
    v_mov_b32 v210, 0
    v_mov_b32 v211, 0
    v_mov_b32 v245, 0
K2_ROUND:
    v_lshlrev_b32 v243, 4, v0
    v_lshrrev_b32 v216, 3, v0
    v_lshlrev_b32 v217, 8, v216
    s_add_u32 s40, s3, 0x1100000
    buffer_load_ubyte v212, v217, s[16:19], s40 offen
    s_add_u32 s40, s3, 0x1104000
    buffer_load_ubyte v213, v217, s[16:19], s40 offen
    s_add_u32 s40, s3, 0x1108000
    buffer_load_ubyte v214, v217, s[16:19], s40 offen
    s_add_u32 s40, s3, 0x110c000
    buffer_load_ubyte v215, v217, s[16:19], s40 offen
    s_lshl_b32 s44, s24, 11
    s_cmp_ge_u32 s24, 4
    s_cselect_b32 s45, 0x1fd80, 0
    s_add_u32 s45, s45, 0x4200
    s_add_u32 m0, s44, s45
    s_add_u32 s44, s44, 0x1540000
    buffer_load_dwordx4 v5, s[16:19], s44 offen lds
    buffer_load_dwordx4 v5, s[16:19], s44 offen offset:1024 lds
    v_add_u32 v218, s25, v216
    v_xor_b32 v219, v216, v0
    v_and_b32 v219, 7, v219
    v_lshlrev_b32 v219, 4, v219
    s_lshl_b32 s45, s24, 10
    s_add_u32 m0, s45, 0x23f80
    s_lshl_b32 s44, s24, 11
    buffer_load_dwordx4 v[218:219], s[12:15], 0 idxen offen lds
    s_add_u32 s44, s44, 0x1544800
    buffer_load_dwordx4 v[72:75], v5, s[16:19], s44 offen offset:0
    buffer_load_dwordx4 v[76:79], v5, s[16:19], s44 offen offset:1024
    s_and_b32 s45, s45, 1024
    s_add_u32 m0, s45, 0x23710
    s_add_u32 s45, s45, 0x1544000
    s_cmp_ge_u32 s24, 2
    s_cselect_b64 exec, 1, -1
    buffer_load_dwordx4 v5, s[16:19], s45 offen lds
    s_mov_b64 exec, -1
    s_lshl_b32 s40, s3, 15
    s_add_u32 s41, s40, 0x2000
    s_add_u32 s42, s40, 0x4000
    s_add_u32 s43, s40, 0x6000
    s_cmp_lg_u32 s27, 0
    s_cbranch_scc1 K2_RL1
    buffer_load_dwordx4 v[88:91], v243, s[16:19], s40 offen
    buffer_load_dwordx4 v[96:99], v243, s[16:19], s41 offen
K2_RL2:
    v_and_b32 v246, 7, v0
    s_mul_i32 s47, s27, 32
    v_add_u32 v246, s47, v246
    s_movk_i32 s45, 20000
    v_mul_u32_u24 v247, s45, v216
    v_lshl_add_u32 v247, v246, 3, v247
    s_add_u32 s47, s47, 32
    v_mov_b32 v120, 0
    v_mov_b32 v121, 0
    v_mov_b32 v122, 0
    v_mov_b32 v123, 0
    v_mov_b32 v124, s82
    v_mov_b32 v125, s82
    v_mov_b32 v126, s82
    v_mov_b32 v127, s82
    v_mov_b32 v128, 0x92700000
    v_mov_b32 v129, v128
    v_mov_b32 v130, v128
    v_mov_b32 v131, v128
    v_mov_b32 v132, 0x8bf08be0
    v_mov_b32 v133, v132
    v_mov_b32 v134, v132
    v_mov_b32 v135, v132
    v_add_u32 v220, 0xc200, v243
    ds_write_b128 v220, v[124:127] offset:0
    ds_write_b128 v220, v[124:127] offset:8192
    ds_write_b128 v220, v[124:127] offset:16384
    ds_write_b128 v220, v[124:127] offset:24576
    v_add_u32 v221, 0x1e280, v4
    s_cmp_lg_u32 s24, 4
    s_cbranch_scc1 K2_I0
    ds_write_b64 v221, v[120:121]
K2_I0:
    s_cmp_ge_u32 s24, 5
    s_cbranch_scc1 K2_I1
    ds_write_b128 v243, v[128:131] offset:1024
    ds_write_b128 v243, v[132:135] offset:6144
    s_cmp_ge_u32 s24, 3
    s_cbranch_scc1 K2_I2
    ds_write_b128 v220, v[124:127] offset:32768
    s_branch K2_I2
K2_I1:
    s_cmp_eq_u32 s24, 5
    s_cbranch_scc1 K2_I3
    s_cmp_eq_u32 s24, 6
    s_cbranch_scc1 K2_I4
    v_lshlrev_b32 v221, 2, v1
    v_lshlrev_b32 v222, 9, v1
    ds_write_b32 v221, v222 offset:512
    ds_write_b32 v221, v120 offset:768
    s_branch K2_I2
K2_I4:
    ds_write_b64 v4, v[120:121] offset:16384
    s_branch K2_I2
K2_I3:
    v_lshrrev_b32 v221, 3, v1
    v_xor_b32 v221, v221, v1
    v_and_b32 v221, 4, v221
    v_and_b32 v222, 1, v1
    v_or_b32 v221, v221, v222
    v_mov_b32 v222, 0x3f803f80
    v_cmp_eq_u32 vcc, 0, v221
    v_cmp_eq_u32 s[44:45], 1, v221
    s_nop 1
    v_cndmask_b32 v132, 0, v222, vcc
    v_cndmask_b32 v133, 0, v222, s[44:45]
    ds_write_b64 v4, v[132:133]
K2_I2:
    v_bfe_u32 v217, v1, 2, 1
    v_and_b32 v218, 1, v1
    v_lshl_add_u32 v217, v217, 1, v218
    v_bfe_u32 v218, v1, 3, 2
    v_bfe_u32 v219, v1, 1, 1
    v_lshl_add_u32 v218, v218, 1, v219
    v_lshlrev_b32 v240, 2, v217
    v_lshlrev_b32 v249, 2, v218
    v_and_b32 v220, 3, v218
    v_lshlrev_b32 v220, 3, v220
    v_lshl_add_u32 v220, v217, 1, v220
    v_lshrrev_b32 v221, 2, v218
    v_add_u32 v220, v220, v221
    v_lshlrev_b32 v220, 7, v220
    v_add_u32 v220, s36, v220
    v_lshl_add_u32 v221, v217, 1, v219
    v_lshrrev_b32 v222, 5, v1
    v_xor_b32 v221, v221, v222
    v_xor_b32 v192, 0, v221
    v_lshl_add_u32 v192, v192, 4, v220
    v_xor_b32 v193, 2, v221
    v_lshl_add_u32 v193, v193, 4, v220
    v_xor_b32 v194, 4, v221
    v_lshl_add_u32 v194, v194, 4, v220
    v_xor_b32 v195, 6, v221
    v_lshl_add_u32 v195, v195, 4, v220
    v_lshrrev_b32 v220, 3, v1
    v_and_b32 v221, 6, v220
    v_xor_b32 v221, v221, v1
    v_and_b32 v221, 7, v221
    v_lshlrev_b32 v185, 4, v221
    v_xor_b32 v187, 16, v185
    v_mov_b32 v189, v185
    v_mov_b32 v191, v187
    v_lshlrev_b32 v241, 1, v220
    v_lshlrev_b32 v242, 3, v222
    v_mov_b32 v161, 0
    v_mov_b32 v165, 0
    v_mov_b32 v169, 0
    v_mov_b32 v173, 0
    v_mov_b32 v177, 0
    v_mov_b32 v181, 0
    v_mov_b32 v6, 0
    v_add_u32 v223, 0x4200, v5
    s_waitcnt vmcnt(2) lgkmcnt(0)
    s_barrier
    s_cmp_lg_u32 s27, 0
    s_cbranch_scc1 K2_RL3
    s_lshl_b32 s40, s3, 15
    s_add_u32 s42, s40, 0x4000
    buffer_load_dwordx4 v[104:107], v243, s[16:19], s42 offen
    s_add_u32 s43, s40, 0x6000
    buffer_load_dwordx4 v[112:115], v243, s[16:19], s43 offen
    v_sub_u32 v218, v212, v246
    v_cmp_lt_i32 s[48:49], 0, v218
    v_cmp_lt_i32 s[50:51], 8, v218
    v_cmp_lt_i32 s[52:53], 16, v218
    v_cmp_lt_i32 s[54:55], 24, v218
    v_sub_u32 v218, v213, v246
    v_cmp_lt_i32 s[56:57], 0, v218
    v_cmp_lt_i32 s[58:59], 8, v218
    v_cmp_lt_i32 s[60:61], 16, v218
    v_cmp_lt_i32 s[62:63], 24, v218
    v_sub_u32 v218, v214, v246
    v_cmp_lt_i32 s[64:65], 0, v218
    v_cmp_lt_i32 s[66:67], 8, v218
    v_cmp_lt_i32 s[68:69], 16, v218
    v_cmp_lt_i32 s[70:71], 24, v218
    v_sub_u32 v218, v215, v246
    v_cmp_lt_i32 s[72:73], 0, v218
    v_cmp_lt_i32 s[74:75], 8, v218
    v_cmp_lt_i32 s[76:77], 16, v218
    v_cmp_lt_i32 s[78:79], 24, v218
    s_or_b64 s[40:41], s[54:55], s[62:63]
    s_or_b64 s[42:43], s[70:71], s[78:79]
    s_or_b64 s[40:41], s[40:41], s[42:43]
    s_cbranch_scc1 K2_BL
K2_RL3:
    ds_read_b128 v[8:11], v223 offset:0
    ds_read_b128 v[12:15], v223 offset:1024
    ds_read_b128 v[16:19], v223 offset:2048
    ds_read_b128 v[20:23], v223 offset:3072
    ds_read_b128 v[24:27], v223 offset:4096
    ds_read_b128 v[28:31], v223 offset:5120
    ds_read_b128 v[32:35], v223 offset:6144
    ds_read_b128 v[36:39], v223 offset:7168
    v_and_b32 v216, 15, v1
    v_lshrrev_b32 v217, 4, v1
    v_and_b32 v218, 7, v1
    v_xor_b32 v218, v218, v217
    v_lshlrev_b32 v218, 4, v218
    v_lshl_add_u32 v218, v216, 7, v218
    v_add_u32 v218, 0x23f80, v218
    v_xor_b32 v219, 64, v218
    s_lshl_b32 s44, s24, 6
    v_lshl_add_u32 v216, v216, 2, s44
    v_add_u32 v220, 0x23b10, v216
    s_movk_i32 s44, 2112
    v_mad_u32_u24 v216, v217, s44, v216
    v_add_u32 v216, 0x1e490, v216
    v_lshlrev_b32 v222, 2, v1
    v_add_u32 v222, 0x23710, v222
    s_mov_b32 s44, 0xbfb8aa3b
    s_mov_b32 s45, 0xffff0000
    ds_read_b128 v[136:139], v218 offset:0
    ds_read_b128 v[140:143], v219 offset:0
    ds_read_b128 v[144:147], v218 offset:2048
    ds_read_b128 v[148:151], v219 offset:2048
    ds_read_b128 v[152:155], v218 offset:4096
    ds_read_b128 v[156:159], v219 offset:4096
    ds_read_b32 v223, v220
    ds_read_b32 v160, v222 offset:0
    ds_read_b32 v164, v222 offset:256
    ds_read_b32 v168, v222 offset:512
    ds_read_b32 v172, v222 offset:768
    s_waitcnt lgkmcnt(10)
    v_mfma_f32_16x16x32_bf16 v[120:123], v[136:139], v[72:75], 0
    s_waitcnt lgkmcnt(9)
    v_mfma_f32_16x16x32_bf16 v[120:123], v[140:143], v[76:79], v[120:123]
    s_waitcnt lgkmcnt(8)
    v_mfma_f32_16x16x32_bf16 v[124:127], v[144:147], v[72:75], 0
    s_waitcnt lgkmcnt(7)
    v_mfma_f32_16x16x32_bf16 v[124:127], v[148:151], v[76:79], v[124:127]
    s_waitcnt lgkmcnt(6)
    v_mfma_f32_16x16x32_bf16 v[128:131], v[152:155], v[72:75], 0
    s_waitcnt lgkmcnt(5)
    v_mfma_f32_16x16x32_bf16 v[128:131], v[156:159], v[76:79], v[128:131]
    s_waitcnt lgkmcnt(4)
    v_mov_b32 v222, v223
    s_mov_b32 s46, 0x07060302
    v_pk_fma_f32 v[120:121], v[120:121], s[44:45], v[222:223] op_sel_hi:[1,0,1]
    v_pk_fma_f32 v[122:123], v[122:123], s[44:45], v[222:223] op_sel_hi:[1,0,1]
    v_pk_fma_f32 v[124:125], v[124:125], s[44:45], v[222:223] op_sel_hi:[1,0,1]
    v_pk_fma_f32 v[126:127], v[126:127], s[44:45], v[222:223] op_sel_hi:[1,0,1]
    s_nop 0
    v_pk_fma_f32 v[128:129], v[128:129], s[44:45], v[222:223] op_sel_hi:[1,0,1]
    v_pk_fma_f32 v[130:131], v[130:131], s[44:45], v[222:223] op_sel_hi:[1,0,1]
    v_and_b32 v136, s45, v120
    v_and_b32 v137, s45, v121
    v_pk_add_f32 v[136:137], v[120:121], v[136:137] neg_lo:[0,1] neg_hi:[0,1]
    v_perm_b32 v136, v120, v136, s46
    ds_write_b32 v216, v136 offset:0
    v_perm_b32 v137, v121, v137, s46
    ds_write_b32 v216, v137 offset:528
    v_and_b32 v138, s45, v122
    v_and_b32 v139, s45, v123
    v_pk_add_f32 v[138:139], v[122:123], v[138:139] neg_lo:[0,1] neg_hi:[0,1]
    v_perm_b32 v138, v122, v138, s46
    ds_write_b32 v216, v138 offset:1056
    v_perm_b32 v139, v123, v139, s46
    ds_write_b32 v216, v139 offset:1584
    v_and_b32 v140, s45, v124
    v_and_b32 v141, s45, v125
    v_pk_add_f32 v[140:141], v[124:125], v[140:141] neg_lo:[0,1] neg_hi:[0,1]
    v_perm_b32 v140, v124, v140, s46
    ds_write_b32 v216, v140 offset:8448
    v_perm_b32 v141, v125, v141, s46
    ds_write_b32 v216, v141 offset:8976
    v_and_b32 v142, s45, v126
    v_and_b32 v143, s45, v127
    v_pk_add_f32 v[142:143], v[126:127], v[142:143] neg_lo:[0,1] neg_hi:[0,1]
    v_perm_b32 v142, v126, v142, s46
    ds_write_b32 v216, v142 offset:9504
    v_perm_b32 v143, v127, v143, s46
    ds_write_b32 v216, v143 offset:10032
    s_mov_b32 exec_hi, 0
    v_and_b32 v144, s45, v128
    v_and_b32 v145, s45, v129
    v_pk_add_f32 v[144:145], v[128:129], v[144:145] neg_lo:[0,1] neg_hi:[0,1]
    v_perm_b32 v144, v128, v144, s46
    ds_write_b32 v216, v144 offset:16896
    v_perm_b32 v145, v129, v145, s46
    ds_write_b32 v216, v145 offset:17424
    v_and_b32 v146, s45, v130
    v_and_b32 v147, s45, v131
    v_pk_add_f32 v[146:147], v[130:131], v[146:147] neg_lo:[0,1] neg_hi:[0,1]
    v_perm_b32 v146, v130, v146, s46
    ds_write_b32 v216, v146 offset:17952
    v_perm_b32 v147, v131, v147, s46
    ds_write_b32 v216, v147 offset:18480
    s_mov_b64 exec, -1
    v_mov_b32 v217, 4
    s_cmp_lg_u32 s27, 0
    s_cbranch_scc1 K2_RM1
    s_waitcnt vmcnt(3)
    v_bfe_u32 v92, v91, 0, 8
    v_bfe_u32 v93, v91, 8, 8
    v_bfe_u32 v91, v91, 16, 8
    s_mov_b64 exec, s[48:49]
    ds_add_rtn_u32 v136, v92, v217 offset:512
    s_mov_b64 exec, s[50:51]
    ds_add_rtn_u32 v137, v93, v217 offset:512
    s_mov_b64 exec, -1
    s_waitcnt vmcnt(2)
    v_bfe_u32 v100, v99, 0, 8
    v_bfe_u32 v101, v99, 8, 8
    v_bfe_u32 v99, v99, 16, 8
    s_mov_b64 exec, s[56:57]
    ds_add_rtn_u32 v140, v100, v217 offset:512
    s_mov_b64 exec, s[58:59]
    ds_add_rtn_u32 v141, v101, v217 offset:512
    s_mov_b64 exec, -1
    s_waitcnt vmcnt(1)
    v_bfe_u32 v108, v107, 0, 8
    v_bfe_u32 v109, v107, 8, 8
    v_bfe_u32 v107, v107, 16, 8
    s_mov_b64 exec, s[64:65]
    ds_add_rtn_u32 v144, v108, v217 offset:512
    s_mov_b64 exec, s[66:67]
    ds_add_rtn_u32 v145, v109, v217 offset:512
    s_mov_b64 exec, -1
    s_waitcnt vmcnt(0)
    v_bfe_u32 v116, v115, 0, 8
    v_bfe_u32 v117, v115, 8, 8
    v_bfe_u32 v115, v115, 16, 8
    s_mov_b64 exec, s[72:73]
    ds_add_rtn_u32 v148, v116, v217 offset:512
    s_mov_b64 exec, s[74:75]
    ds_add_rtn_u32 v149, v117, v217 offset:512
    s_mov_b64 exec, -1
K2_RM2:
    s_lshr_b32 s44, s2, 3
    s_mulk_i32 s44, 313
    v_add_u32 v220, s44, v0
    v_cmp_gt_u32 vcc, 313, v0
    s_or_b64 exec, vcc, 1
    buffer_load_dword v248, v220, s[12:15], 0 idxen
    s_mov_b64 exec, -1
    v_max3_u32 v218, v212, v213, v214
    v_max_u32 v218, v218, v215
    v_cmp_lt_u32 s[84:85], s47, v218
    s_cmp_eq_u64 s[52:53], 0
    s_cbranch_scc1 K2_P1S0
    s_mov_b64 exec, s[52:53]
    ds_add_rtn_u32 v138, v91, v217 offset:512
    s_cmp_lg_u64 s[54:55], 0
    s_cbranch_scc1 K2_P1B0
K2_P1S0:
    s_cmp_eq_u64 s[60:61], 0
    s_cbranch_scc1 K2_P1S1
    s_mov_b64 exec, s[60:61]
    ds_add_rtn_u32 v142, v99, v217 offset:512
    s_cmp_lg_u64 s[62:63], 0
    s_cbranch_scc1 K2_P1B1
K2_P1S1:
    s_cmp_eq_u64 s[68:69], 0
    s_cbranch_scc1 K2_P1S2
    s_mov_b64 exec, s[68:69]
    ds_add_rtn_u32 v146, v107, v217 offset:512
    s_cmp_lg_u64 s[70:71], 0
    s_cbranch_scc1 K2_P1B2
K2_P1S2:
    s_cmp_eq_u64 s[76:77], 0
    s_cbranch_scc1 K2_P1S3
    s_mov_b64 exec, s[76:77]
    ds_add_rtn_u32 v150, v115, v217 offset:512
    s_cmp_lg_u64 s[78:79], 0
    s_cbranch_scc1 K2_P1B3
K2_P1S3:
    s_waitcnt lgkmcnt(0)
    s_mov_b64 exec, s[48:49]
    ds_write_b32 v136, v88 offset:49664
    s_mov_b64 exec, s[50:51]
    ds_write_b32 v137, v89 offset:49664
    s_mov_b64 exec, s[56:57]
    ds_write_b32 v140, v96 offset:49664
    s_mov_b64 exec, s[58:59]
    ds_write_b32 v141, v97 offset:49664
    s_mov_b64 exec, s[64:65]
    ds_write_b32 v144, v104 offset:49664
    s_mov_b64 exec, s[66:67]
    ds_write_b32 v145, v105 offset:49664
    s_mov_b64 exec, s[72:73]
    ds_write_b32 v148, v112 offset:49664
    s_mov_b64 exec, s[74:75]
    ds_write_b32 v149, v113 offset:49664
    s_cmp_eq_u64 s[52:53], 0
    s_cbranch_scc1 K2_P2S0
    s_mov_b64 exec, s[52:53]
    ds_write_b32 v138, v90 offset:49664
    s_mov_b64 exec, s[54:55]
    ds_write_b32 v139, v94 offset:49664
K2_P2S0:
    s_cmp_eq_u64 s[60:61], 0
    s_cbranch_scc1 K2_P2S1
    s_mov_b64 exec, s[60:61]
    ds_write_b32 v142, v98 offset:49664
    s_mov_b64 exec, s[62:63]
    ds_write_b32 v143, v102 offset:49664
K2_P2S1:
    s_cmp_eq_u64 s[68:69], 0
    s_cbranch_scc1 K2_P2S2
    s_mov_b64 exec, s[68:69]
    ds_write_b32 v146, v106 offset:49664
    s_mov_b64 exec, s[70:71]
    ds_write_b32 v147, v110 offset:49664
K2_P2S2:
    s_cmp_eq_u64 s[76:77], 0
    s_cbranch_scc1 K2_P2S3
    s_mov_b64 exec, s[76:77]
    ds_write_b32 v150, v114 offset:49664
    s_mov_b64 exec, s[78:79]
    ds_write_b32 v151, v118 offset:49664
K2_P2S3:
    s_mov_b64 exec, -1
    s_cmp_eq_u64 s[84:85], 0
    s_cbranch_scc1 K2_NOMORE
    v_mov_b32 v217, 768
    ds_write_b32 v217, v217
K2_NOMORE:
    s_movk_i32 s44, 5462
    v_mul_u32_u24 v226, s44, v0
    v_lshrrev_b32 v226, 16, v226
    v_mad_i32_i24 v227, v226, -12, v0
    v_lshlrev_b32 v227, 5, v227
    v_lshlrev_b32 v222, 2, v1
    v_lshlrev_b32 v218, 2, v226
    s_lshl_b32 s40, s24, 6
    v_and_b32 v217, 15, v1
    v_lshl_add_u32 v217, v217, 2, s40
    v_lshlrev_b32 v223, 9, v1
    s_waitcnt vmcnt(1) lgkmcnt(0)
    s_barrier
    ds_read_b32 v244, v222 offset:512
    s_movk_i32 s41, 512
    s_waitcnt lgkmcnt(0)
    v_sub_u32 v244, v244, v223
    v_add_u32 v216, 28, v244
    v_and_b32 v216, -32, v216
    v_mov_b32 v243, v216
    v_cmp_lt_u32 s[80:81], s41, v244
    s_nop 1
    v_add_u32_dpp v243, v243, v243 row_shr:1 row_mask:0xf bank_mask:0xf bound_ctrl:0
    s_nop 1
    v_add_u32_dpp v243, v243, v243 row_shr:2 row_mask:0xf bank_mask:0xf bound_ctrl:0
    s_nop 1
    v_add_u32_dpp v243, v243, v243 row_shr:4 row_mask:0xf bank_mask:0xf bound_ctrl:0
    s_nop 1
    v_add_u32_dpp v243, v243, v243 row_shr:8 row_mask:0xf bank_mask:0xf bound_ctrl:0
    s_nop 1
    v_add_u32_dpp v243, v243, v243 row_bcast:15 row_mask:0xa bank_mask:0xf
    s_nop 1
    v_add_u32_dpp v243, v243, v243 row_bcast:31 row_mask:0xc bank_mask:0xf
    s_nop 0
    v_readlane_b32 s40, v243, 63
    v_sub_u32 v243, v243, v216
    ds_bpermute_b32 v219, v218, v243
    ds_bpermute_b32 v220, v218, v216
    s_add_u32 s29, s40, 480
    s_lshr_b32 s29, s29, 9
    s_max_u32 s29, s29, 2
    v_cvt_f32_u32 v221, s29
    ds_bpermute_b32 v246, v217, v243
    ds_bpermute_b32 v244, v217, v244
    v_rcp_f32 v221, v221
    s_add_u32 s30, s29, 1
    s_lshr_b32 s30, s30, 1
    s_lshl_b32 s34, s29, 5
    v_mul_f32 v221, 0x4a800000, v221
    v_cvt_u32_f32 v221, v221
    s_sub_i32 s34, 0, s34
    v_readfirstlane_b32 s31, v221
    s_lshl_b32 s30, s30, 5
    s_add_u32 s31, s31, 2
    v_lshl_add_u32 v217, v226, 9, v227
    s_cmp_lg_u64 s[80:81], 0
    s_cbranch_scc1 K2_OVF
K2_NOOVF:
    s_movk_i32 s42, 528
    v_lshl_or_b32 v217, v217, 16, v217
    v_add_u32 v217, 0x100000, v217
    v_mul_u32_u24 v218, s42, v226
    s_waitcnt lgkmcnt(2)
    v_add_u32 v220, v220, v219
    v_add_u32 v219, v219, v227
    v_cmp_lt_u32 vcc, v219, v220
    s_and_b64 exec, exec, vcc
    s_cbranch_execz K2_GQE
K2_GQL:
    v_mul_u32_u24 v221, s31, v219
    v_lshrrev_b32 v221, 27, v221
    v_mad_i32_i24 v222, v221, s34, v219
    v_cmp_le_u32 vcc, s30, v222
    v_lshl_add_u32 v223, v221, 1, v226
    v_lshlrev_b32 v222, 1, v222
    v_lshl_add_u32 v222, v221, 2, v222
    v_addc_co_u32 v223, vcc, 0, v223, vcc
    v_add_u32 v219, 384, v219
    v_mul_u32_u24 v223, s42, v223
    v_cmp_lt_u32 vcc, v219, v220
    v_lshl_or_b32 v223, v223, 16, v218
    ds_write2st64_b32 v222, v223, v217 offset0:4 offset1:24
    v_add_u32 v217, 0x1800180, v217
    s_and_b64 exec, exec, vcc
    s_cbranch_execnz K2_GQL
K2_GQE:
    s_mov_b64 exec, -1
    s_lshr_b32 s43, s30, 5
    s_sub_u32 s44, s29, s43
    s_cmp_lt_u32 s24, 4
    s_cselect_b32 s33, s43, s44
    s_cselect_b32 s43, 0, s30
    s_and_b32 s44, s24, 3
    s_lshl_b32 s43, s43, 1
    s_lshl_b32 s44, s44, 4
    s_add_u32 s43, s43, s44
    v_add_u32 v242, s43, v242
    v_add_u32 v240, s43, v240
    v_add_u32 v241, s43, v241
    v_lshl_add_u32 v7, v1, 6, s43
    s_waitcnt lgkmcnt(0)
    s_barrier
    ds_read_u16 v190, v241 offset:6144
    ds_read_u16 v176, v240 offset:6144
    ds_read_u16 v180, v240 offset:6208
    s_waitcnt lgkmcnt(2)
    ds_read_u16 v184, v190 offset:49664
    ds_read_u16 v186, v190 offset:49668
    ds_read_u16 v188, v190 offset:49672
    ds_read_u16 v190, v190 offset:49676
    s_waitcnt lgkmcnt(0)
    s_mov_b32 m0, s36
    s_nop 0
    buffer_load_dwordx4 v[184:185], s[12:15], 0 idxen offen lds
    s_mov_b32 m0, s37
    s_nop 0
    buffer_load_dwordx4 v[186:187], s[12:15], 0 idxen offen lds
    s_mov_b32 m0, s38
    s_nop 0
    buffer_load_dwordx4 v[188:189], s[12:15], 0 idxen offen lds
    s_mov_b32 m0, s39
    s_nop 0
    buffer_load_dwordx4 v[190:191], s[12:15], 0 idxen offen lds
    ds_read_b64 v[236:237], v242 offset:1024
    v_add_u32 v176, v176, v249
    ds_read_b32 v176, v176 offset:49664
    ds_read_u16 v190, v241 offset:6208
    ds_read_b128 v[120:123], v7 offset:1024
    ds_read_b128 v[124:127], v7 offset:1088
    s_waitcnt lgkmcnt(3)
    v_and_or_b32 v7, v176, s82, v4
    ds_read_b64 v[178:179], v7
    s_waitcnt lgkmcnt(3)
    ds_read_u16 v184, v190 offset:49664
    ds_read_u16 v186, v190 offset:49668
    ds_read_u16 v188, v190 offset:49672
    ds_read_u16 v190, v190 offset:49676
    v_add_u32 v224, 0x25f80, v5
    ds_read_b128 v[40:43], v224 offset:0
    ds_read_b128 v[44:47], v224 offset:1024
    ds_read_b128 v[48:51], v224 offset:2048
    ds_read_b128 v[52:55], v224 offset:3072
    ds_read_b128 v[56:59], v224 offset:4096
    ds_read_b128 v[60:63], v224 offset:5120
    ds_read_b128 v[64:67], v224 offset:6144
    ds_read_b128 v[68:71], v224 offset:7168
    v_add_u32_sdwa v212, v236, v2 dst_sel:DWORD dst_unused:UNUSED_PAD src0_sel:WORD_0 src1_sel:DWORD
    v_add_u32_sdwa v213, v237, v2 dst_sel:DWORD dst_unused:UNUSED_PAD src0_sel:WORD_0 src1_sel:DWORD
    ds_read_b32 v162, v212 offset:0
    ds_read_b32 v163, v213 offset:0
    ds_read_b32 v166, v212 offset:128
    ds_read_b32 v167, v213 offset:128
    ds_read_b32 v170, v212 offset:256
    ds_read_b32 v171, v213 offset:256
    ds_read_b32 v174, v212 offset:384
    ds_read_b32 v175, v213 offset:384
    v_add_u32_sdwa v214, v236, v3 dst_sel:DWORD dst_unused:UNUSED_PAD src0_sel:WORD_1 src1_sel:DWORD
    v_add_u32_sdwa v215, v237, v3 dst_sel:DWORD dst_unused:UNUSED_PAD src0_sel:WORD_1 src1_sel:DWORD
    v_mov_b32 v222, 0
    v_mov_b32 v218, 1.0
    v_mov_b32 v223, 0
    v_mov_b32 v219, 1.0
    v_mov_b32 v228, 0
    v_mov_b32 v229, 0
    v_mov_b32 v230, 0
    v_mov_b32 v231, 0
    v_mov_b32 v232, 0
    v_mov_b32 v233, 0
    v_mov_b32 v234, 0
    v_mov_b32 v235, 0
    s_waitcnt lgkmcnt(15)
    v_cmp_ne_u64 s[48:49], v[120:121], v[124:125]
    v_cmp_ne_u64 vcc, v[122:123], v[126:127]
    s_or_b64 s[48:49], s[48:49], vcc
    s_lshl_b64 s[48:49], s[48:49], 1
    s_waitcnt vmcnt(0)
    ds_read_b128 v[72:75], v192
    ds_read_b128 v[76:79], v193
    ds_read_b128 v[80:83], v194
    ds_read_b128 v[84:87], v195
    s_waitcnt lgkmcnt(3)
    v_mfma_f32_32x32x16_bf16 v[88:103], v[72:75], v[8:11], 0
    s_waitcnt lgkmcnt(2)
    v_mfma_f32_32x32x16_bf16 v[88:103], v[76:79], v[12:15], v[88:103]
    s_waitcnt lgkmcnt(1)
    v_mfma_f32_32x32x16_bf16 v[88:103], v[80:83], v[16:19], v[88:103]
    s_waitcnt lgkmcnt(0)
    v_mfma_f32_32x32x16_bf16 v[88:103], v[84:87], v[20:23], v[88:103]
    s_mov_b32 m0, s36
    s_nop 0
    buffer_load_dwordx4 v[184:185], s[12:15], 0 idxen offen lds
    s_mov_b32 m0, s37
    s_nop 0
    buffer_load_dwordx4 v[186:187], s[12:15], 0 idxen offen lds
    s_mov_b32 m0, s38
    s_nop 0
    buffer_load_dwordx4 v[188:189], s[12:15], 0 idxen offen lds
    s_mov_b32 m0, s39
    s_nop 0
    buffer_load_dwordx4 v[190:191], s[12:15], 0 idxen offen lds
    v_mfma_f32_32x32x16_bf16 v[88:103], v[176:179], v[160:163], v[88:103]
    s_nop 7
    s_cmp_lg_u32 s28, 0
    s_cbranch_scc1 K2_LOOPS
K2_LOOPF:
    s_setprio 1
    v_mfma_f32_32x32x16_bf16 v[104:119], v[72:75], v[24:27], 0
    v_exp_f32 v120, v88
    v_exp_f32 v121, v89
    v_exp_f32 v122, v90
    v_mfma_f32_32x32x16_bf16 v[104:119], v[76:79], v[28:31], v[104:119]
    v_exp_f32 v123, v91
    v_exp_f32 v124, v92
    v_exp_f32 v125, v93
    v_mfma_f32_32x32x16_bf16 v[104:119], v[80:83], v[32:35], v[104:119]
    v_exp_f32 v126, v94
    v_exp_f32 v127, v95
    v_exp_f32 v128, v96
    v_mfma_f32_32x32x16_bf16 v[104:119], v[84:87], v[36:39], v[104:119]
    v_exp_f32 v129, v97
    v_exp_f32 v130, v98
    v_exp_f32 v131, v99
    v_mfma_f32_32x32x16_bf16 v[104:119], v[176:179], v[164:167], v[104:119]
    v_exp_f32 v132, v100
    v_exp_f32 v133, v101
    v_exp_f32 v134, v102
    v_exp_f32 v135, v103
    v_rcp_f32 v226, v218
    v_rcp_f32 v227, v219
    v_pk_add_f32 v[216:217], v[120:121], 1.0 op_sel_hi:[1,0]
    v_pk_fma_f32 v[224:225], v[90:91], v[216:217], v[88:89]
    v_pk_fma_f32 v[234:235], v[222:223], v[226:227], v[234:235]
    v_pk_fma_f32 v[216:217], v[216:217], v[122:123], v[216:217]
    s_bitcmp0_b32 s48, 0
    s_cbranch_scc1 K2_CF_b0_28
    v_cmp_eq_u32 s[52:53], v236, v238
    v_cmp_eq_u32 s[54:55], v237, v239
    ds_write_b32 v214, v228 offset:0
    ds_write_b32 v215, v229 offset:0
    ds_write_b32 v214, v230 offset:128
    ds_write_b32 v215, v231 offset:128
    ds_write_b32 v214, v232 offset:256
    ds_write_b32 v215, v233 offset:256
    ds_write_b32 v214, v234 offset:384
    ds_write_b32 v215, v235 offset:384
    v_add_u32_sdwa v214, v236, v3 dst_sel:DWORD dst_unused:UNUSED_PAD src0_sel:WORD_1 src1_sel:DWORD
    v_add_u32_sdwa v215, v237, v3 dst_sel:DWORD dst_unused:UNUSED_PAD src0_sel:WORD_1 src1_sel:DWORD
    v_cndmask_b32 v226, 0, 1.0, s[52:53]
    v_cndmask_b32 v227, 0, 1.0, s[54:55]
    v_pk_mul_f32 v[228:229], v[228:229], v[226:227]
    v_pk_mul_f32 v[230:231], v[230:231], v[226:227]
    v_pk_mul_f32 v[232:233], v[232:233], v[226:227]
    v_pk_mul_f32 v[234:235], v[234:235], v[226:227]
K2_CF_b0_28:
    ds_read_b64 v[238:239], v242 offset:1088
    v_pk_fma_f32 v[220:221], v[88:89], v[122:123], v[224:225]
    v_pk_fma_f32 v[224:225], v[92:93], v[216:217], v[220:221]
    v_pk_fma_f32 v[216:217], v[216:217], v[124:125], v[216:217]
    v_pk_fma_f32 v[220:221], v[220:221], v[124:125], v[224:225]
    v_pk_fma_f32 v[224:225], v[94:95], v[216:217], v[220:221]
    ds_read_u16 v190, v241 offset:6272
    v_pk_fma_f32 v[216:217], v[216:217], v[126:127], v[216:217]
    v_pk_fma_f32 v[220:221], v[220:221], v[126:127], v[224:225]
    v_pk_fma_f32 v[224:225], v[96:97], v[216:217], v[220:221]
    v_pk_fma_f32 v[216:217], v[216:217], v[128:129], v[216:217]
    s_waitcnt lgkmcnt(2)
    v_add_u32 v180, v180, v249
    ds_read_b32 v180, v180 offset:49664
    v_pk_fma_f32 v[220:221], v[220:221], v[128:129], v[224:225]
    v_pk_fma_f32 v[224:225], v[98:99], v[216:217], v[220:221]
    v_pk_fma_f32 v[216:217], v[216:217], v[130:131], v[216:217]
    v_pk_fma_f32 v[220:221], v[220:221], v[130:131], v[224:225]
    v_pk_fma_f32 v[224:225], v[100:101], v[216:217], v[220:221]
    v_pk_fma_f32 v[216:217], v[216:217], v[132:133], v[216:217]
    v_pk_fma_f32 v[220:221], v[220:221], v[132:133], v[224:225]
    v_pk_fma_f32 v[224:225], v[102:103], v[216:217], v[220:221]
    v_pk_fma_f32 v[216:217], v[216:217], v[134:135], v[216:217]
    v_pk_fma_f32 v[220:221], v[220:221], v[134:135], v[224:225]
    v_max3_f32 v6, v6, v216, v217
    v_mfma_f32_32x32x16_bf16 v[88:103], v[72:75], v[40:43], 0
    v_exp_f32 v120, v104
    v_exp_f32 v121, v105
    v_exp_f32 v122, v106
    v_mfma_f32_32x32x16_bf16 v[88:103], v[76:79], v[44:47], v[88:103]
    v_exp_f32 v123, v107
    v_exp_f32 v124, v108
    v_exp_f32 v125, v109
    v_mfma_f32_32x32x16_bf16 v[88:103], v[80:83], v[48:51], v[88:103]
    v_exp_f32 v126, v110
    v_exp_f32 v127, v111
    v_exp_f32 v128, v112
    v_mfma_f32_32x32x16_bf16 v[88:103], v[84:87], v[52:55], v[88:103]
    v_exp_f32 v129, v113
    v_exp_f32 v130, v114
    v_exp_f32 v131, v115
    v_mfma_f32_32x32x16_bf16 v[88:103], v[176:179], v[168:171], v[88:103]
    v_exp_f32 v132, v116
    v_exp_f32 v133, v117
    v_exp_f32 v134, v118
    v_exp_f32 v135, v119
    v_rcp_f32 v226, v216
    v_rcp_f32 v227, v217
    v_pk_add_f32 v[218:219], v[120:121], 1.0 op_sel_hi:[1,0]
    v_pk_fma_f32 v[224:225], v[106:107], v[218:219], v[104:105]
    v_pk_fma_f32 v[228:229], v[220:221], v[226:227], v[228:229]
    v_pk_fma_f32 v[218:219], v[218:219], v[122:123], v[218:219]
    s_waitcnt lgkmcnt(0)
    v_and_or_b32 v7, v180, s82, v4
    ds_read_b64 v[182:183], v7
    v_pk_fma_f32 v[222:223], v[104:105], v[122:123], v[224:225]
    v_pk_fma_f32 v[224:225], v[108:109], v[218:219], v[222:223]
    v_pk_fma_f32 v[218:219], v[218:219], v[124:125], v[218:219]
    ds_read_u16 v184, v190 offset:49664
    ds_read_u16 v186, v190 offset:49668
    v_pk_fma_f32 v[222:223], v[222:223], v[124:125], v[224:225]
    v_pk_fma_f32 v[224:225], v[110:111], v[218:219], v[222:223]
    v_pk_fma_f32 v[218:219], v[218:219], v[126:127], v[218:219]
    v_pk_fma_f32 v[222:223], v[222:223], v[126:127], v[224:225]
    ds_read_u16 v188, v190 offset:49672
    ds_read_u16 v190, v190 offset:49676
    v_pk_fma_f32 v[224:225], v[112:113], v[218:219], v[222:223]
    v_pk_fma_f32 v[218:219], v[218:219], v[128:129], v[218:219]
    v_pk_fma_f32 v[222:223], v[222:223], v[128:129], v[224:225]
    v_pk_fma_f32 v[224:225], v[114:115], v[218:219], v[222:223]
    v_pk_fma_f32 v[218:219], v[218:219], v[130:131], v[218:219]
    v_pk_fma_f32 v[222:223], v[222:223], v[130:131], v[224:225]
    v_pk_fma_f32 v[224:225], v[116:117], v[218:219], v[222:223]
    v_pk_fma_f32 v[218:219], v[218:219], v[132:133], v[218:219]
    v_pk_fma_f32 v[222:223], v[222:223], v[132:133], v[224:225]
    v_pk_fma_f32 v[224:225], v[118:119], v[218:219], v[222:223]
    v_pk_fma_f32 v[218:219], v[218:219], v[134:135], v[218:219]
    v_pk_fma_f32 v[222:223], v[222:223], v[134:135], v[224:225]
    v_max3_f32 v6, v6, v218, v219
    v_mfma_f32_32x32x16_bf16 v[104:119], v[72:75], v[56:59], 0
    v_exp_f32 v120, v88
    v_exp_f32 v121, v89
    v_exp_f32 v122, v90
    v_mfma_f32_32x32x16_bf16 v[104:119], v[76:79], v[60:63], v[104:119]
    v_exp_f32 v123, v91
    v_exp_f32 v124, v92
    v_exp_f32 v125, v93
    v_mfma_f32_32x32x16_bf16 v[104:119], v[80:83], v[64:67], v[104:119]
    v_exp_f32 v126, v94
    v_exp_f32 v127, v95
    v_exp_f32 v128, v96
    v_mfma_f32_32x32x16_bf16 v[104:119], v[84:87], v[68:71], v[104:119]
    v_exp_f32 v129, v97
    v_exp_f32 v130, v98
    v_exp_f32 v131, v99
    v_mfma_f32_32x32x16_bf16 v[104:119], v[176:179], v[172:175], v[104:119]
    v_exp_f32 v132, v100
    v_exp_f32 v133, v101
    v_exp_f32 v134, v102
    v_exp_f32 v135, v103
    v_rcp_f32 v226, v218
    v_rcp_f32 v227, v219
    s_waitcnt vmcnt(0)
    ds_read_b128 v[72:75], v192
    ds_read_b128 v[76:79], v193
    ds_read_b128 v[80:83], v194
    ds_read_b128 v[84:87], v195
    v_pk_add_f32 v[216:217], v[120:121], 1.0 op_sel_hi:[1,0]
    v_pk_fma_f32 v[224:225], v[90:91], v[216:217], v[88:89]
    v_pk_fma_f32 v[230:231], v[222:223], v[226:227], v[230:231]
    v_pk_fma_f32 v[216:217], v[216:217], v[122:123], v[216:217]
    s_bitcmp0_b32 s48, 1
    s_cbranch_scc1 K2_CF_b0_160
    v_add_u32_sdwa v212, v238, v2 dst_sel:DWORD dst_unused:UNUSED_PAD src0_sel:WORD_0 src1_sel:DWORD
    v_add_u32_sdwa v213, v239, v2 dst_sel:DWORD dst_unused:UNUSED_PAD src0_sel:WORD_0 src1_sel:DWORD
    ds_read_b32 v162, v212 offset:0
    ds_read_b32 v163, v213 offset:0
    ds_read_b32 v166, v212 offset:128
    ds_read_b32 v167, v213 offset:128
    ds_read_b32 v170, v212 offset:256
    ds_read_b32 v171, v213 offset:256
    ds_read_b32 v174, v212 offset:384
    ds_read_b32 v175, v213 offset:384
K2_CF_b0_160:
    v_pk_fma_f32 v[220:221], v[88:89], v[122:123], v[224:225]
    v_pk_fma_f32 v[224:225], v[92:93], v[216:217], v[220:221]
    v_pk_fma_f32 v[216:217], v[216:217], v[124:125], v[216:217]
    v_pk_fma_f32 v[220:221], v[220:221], v[124:125], v[224:225]
    v_pk_fma_f32 v[224:225], v[94:95], v[216:217], v[220:221]
    v_pk_fma_f32 v[216:217], v[216:217], v[126:127], v[216:217]
    v_pk_fma_f32 v[220:221], v[220:221], v[126:127], v[224:225]
    v_pk_fma_f32 v[224:225], v[96:97], v[216:217], v[220:221]
    v_pk_fma_f32 v[216:217], v[216:217], v[128:129], v[216:217]
    v_pk_fma_f32 v[220:221], v[220:221], v[128:129], v[224:225]
    v_pk_fma_f32 v[224:225], v[98:99], v[216:217], v[220:221]
    v_pk_fma_f32 v[216:217], v[216:217], v[130:131], v[216:217]
    v_pk_fma_f32 v[220:221], v[220:221], v[130:131], v[224:225]
    v_pk_fma_f32 v[224:225], v[100:101], v[216:217], v[220:221]
    v_pk_fma_f32 v[216:217], v[216:217], v[132:133], v[216:217]
    v_pk_fma_f32 v[220:221], v[220:221], v[132:133], v[224:225]
    v_pk_fma_f32 v[224:225], v[102:103], v[216:217], v[220:221]
    v_pk_fma_f32 v[216:217], v[216:217], v[134:135], v[216:217]
    v_pk_fma_f32 v[220:221], v[220:221], v[134:135], v[224:225]
    v_max3_f32 v6, v6, v216, v217
    s_setprio 0
    s_waitcnt lgkmcnt(0)
    s_waitcnt lgkmcnt(0)
    v_mfma_f32_32x32x16_bf16 v[88:103], v[72:75], v[8:11], 0
    v_exp_f32 v120, v104
    v_exp_f32 v121, v105
    v_exp_f32 v122, v106
    v_mfma_f32_32x32x16_bf16 v[88:103], v[76:79], v[12:15], v[88:103]
    v_exp_f32 v123, v107
    v_exp_f32 v124, v108
    v_exp_f32 v125, v109
    v_mfma_f32_32x32x16_bf16 v[88:103], v[80:83], v[16:19], v[88:103]
    v_exp_f32 v126, v110
    v_exp_f32 v127, v111
    v_exp_f32 v128, v112
    v_mfma_f32_32x32x16_bf16 v[88:103], v[84:87], v[20:23], v[88:103]
    v_exp_f32 v129, v113
    v_exp_f32 v130, v114
    v_exp_f32 v131, v115
    v_mfma_f32_32x32x16_bf16 v[88:103], v[180:183], v[160:163], v[88:103]
    v_exp_f32 v132, v116
    v_exp_f32 v133, v117
    v_exp_f32 v134, v118
    v_exp_f32 v135, v119
    v_rcp_f32 v226, v216
    v_rcp_f32 v227, v217
    v_pk_add_f32 v[218:219], v[120:121], 1.0 op_sel_hi:[1,0]
    v_pk_fma_f32 v[224:225], v[106:107], v[218:219], v[104:105]
    v_pk_fma_f32 v[232:233], v[220:221], v[226:227], v[232:233]
    s_mov_b32 m0, s36
    v_pk_fma_f32 v[218:219], v[218:219], v[122:123], v[218:219]
    buffer_load_dwordx4 v[184:185], s[12:15], 0 idxen offen lds
    v_pk_fma_f32 v[222:223], v[104:105], v[122:123], v[224:225]
    v_pk_fma_f32 v[224:225], v[108:109], v[218:219], v[222:223]
    v_pk_fma_f32 v[218:219], v[218:219], v[124:125], v[218:219]
    s_mov_b32 m0, s37
    v_pk_fma_f32 v[222:223], v[222:223], v[124:125], v[224:225]
    buffer_load_dwordx4 v[186:187], s[12:15], 0 idxen offen lds
    v_pk_fma_f32 v[224:225], v[110:111], v[218:219], v[222:223]
    v_pk_fma_f32 v[218:219], v[218:219], v[126:127], v[218:219]
    v_pk_fma_f32 v[222:223], v[222:223], v[126:127], v[224:225]
    s_mov_b32 m0, s38
    v_pk_fma_f32 v[224:225], v[112:113], v[218:219], v[222:223]
    buffer_load_dwordx4 v[188:189], s[12:15], 0 idxen offen lds
    v_pk_fma_f32 v[218:219], v[218:219], v[128:129], v[218:219]
    v_pk_fma_f32 v[222:223], v[222:223], v[128:129], v[224:225]
    v_pk_fma_f32 v[224:225], v[114:115], v[218:219], v[222:223]
    s_mov_b32 m0, s39
    v_pk_fma_f32 v[218:219], v[218:219], v[130:131], v[218:219]
    buffer_load_dwordx4 v[190:191], s[12:15], 0 idxen offen lds
    v_pk_fma_f32 v[222:223], v[222:223], v[130:131], v[224:225]
    v_pk_fma_f32 v[224:225], v[116:117], v[218:219], v[222:223]
    ds_read_u16 v176, v240 offset:6272
    v_pk_fma_f32 v[218:219], v[218:219], v[132:133], v[218:219]
    s_lshr_b64 s[48:49], s[48:49], 1
    v_pk_fma_f32 v[222:223], v[222:223], v[132:133], v[224:225]
    v_pk_fma_f32 v[224:225], v[118:119], v[218:219], v[222:223]
    v_pk_fma_f32 v[218:219], v[218:219], v[134:135], v[218:219]
    v_pk_fma_f32 v[222:223], v[222:223], v[134:135], v[224:225]
    v_max3_f32 v6, v6, v218, v219
    s_sub_u32 s33, s33, 1
    s_cmp_eq_u32 s33, 0
    s_cbranch_scc1 K2_DRF
    s_setprio 1
    v_mfma_f32_32x32x16_bf16 v[104:119], v[72:75], v[24:27], 0
    v_exp_f32 v120, v88
    v_exp_f32 v121, v89
    v_exp_f32 v122, v90
    v_mfma_f32_32x32x16_bf16 v[104:119], v[76:79], v[28:31], v[104:119]
    v_exp_f32 v123, v91
    v_exp_f32 v124, v92
    v_exp_f32 v125, v93
    v_mfma_f32_32x32x16_bf16 v[104:119], v[80:83], v[32:35], v[104:119]
    v_exp_f32 v126, v94
    v_exp_f32 v127, v95
    v_exp_f32 v128, v96
    v_mfma_f32_32x32x16_bf16 v[104:119], v[84:87], v[36:39], v[104:119]
    v_exp_f32 v129, v97
    v_exp_f32 v130, v98
    v_exp_f32 v131, v99
    v_mfma_f32_32x32x16_bf16 v[104:119], v[180:183], v[164:167], v[104:119]
    v_exp_f32 v132, v100
    v_exp_f32 v133, v101
    v_exp_f32 v134, v102
    v_exp_f32 v135, v103
    v_rcp_f32 v226, v218
    v_rcp_f32 v227, v219
    v_pk_add_f32 v[216:217], v[120:121], 1.0 op_sel_hi:[1,0]
    v_pk_fma_f32 v[224:225], v[90:91], v[216:217], v[88:89]
    v_pk_fma_f32 v[234:235], v[222:223], v[226:227], v[234:235]
    v_pk_fma_f32 v[216:217], v[216:217], v[122:123], v[216:217]
    s_bitcmp0_b32 s48, 0
    s_cbranch_scc1 K2_CF_b1_28
    v_cmp_eq_u32 s[52:53], v236, v238
    v_cmp_eq_u32 s[54:55], v237, v239
    ds_write_b32 v214, v228 offset:0
    ds_write_b32 v215, v229 offset:0
    ds_write_b32 v214, v230 offset:128
    ds_write_b32 v215, v231 offset:128
    ds_write_b32 v214, v232 offset:256
    ds_write_b32 v215, v233 offset:256
    ds_write_b32 v214, v234 offset:384
    ds_write_b32 v215, v235 offset:384
    v_add_u32_sdwa v214, v238, v3 dst_sel:DWORD dst_unused:UNUSED_PAD src0_sel:WORD_1 src1_sel:DWORD
    v_add_u32_sdwa v215, v239, v3 dst_sel:DWORD dst_unused:UNUSED_PAD src0_sel:WORD_1 src1_sel:DWORD
    v_cndmask_b32 v226, 0, 1.0, s[52:53]
    v_cndmask_b32 v227, 0, 1.0, s[54:55]
    v_pk_mul_f32 v[228:229], v[228:229], v[226:227]
    v_pk_mul_f32 v[230:231], v[230:231], v[226:227]
    v_pk_mul_f32 v[232:233], v[232:233], v[226:227]
    v_pk_mul_f32 v[234:235], v[234:235], v[226:227]
K2_CF_b1_28:
    ds_read_b64 v[236:237], v242 offset:1152
    v_pk_fma_f32 v[220:221], v[88:89], v[122:123], v[224:225]
    v_pk_fma_f32 v[224:225], v[92:93], v[216:217], v[220:221]
    v_pk_fma_f32 v[216:217], v[216:217], v[124:125], v[216:217]
    v_pk_fma_f32 v[220:221], v[220:221], v[124:125], v[224:225]
    v_pk_fma_f32 v[224:225], v[94:95], v[216:217], v[220:221]
    ds_read_u16 v190, v241 offset:6336
    v_pk_fma_f32 v[216:217], v[216:217], v[126:127], v[216:217]
    v_pk_fma_f32 v[220:221], v[220:221], v[126:127], v[224:225]
    v_pk_fma_f32 v[224:225], v[96:97], v[216:217], v[220:221]
    v_pk_fma_f32 v[216:217], v[216:217], v[128:129], v[216:217]
    s_waitcnt lgkmcnt(2)
    v_add_u32 v176, v176, v249
    ds_read_b32 v176, v176 offset:49664
    v_pk_fma_f32 v[220:221], v[220:221], v[128:129], v[224:225]
    v_pk_fma_f32 v[224:225], v[98:99], v[216:217], v[220:221]
    v_pk_fma_f32 v[216:217], v[216:217], v[130:131], v[216:217]
    v_pk_fma_f32 v[220:221], v[220:221], v[130:131], v[224:225]
    v_pk_fma_f32 v[224:225], v[100:101], v[216:217], v[220:221]
    v_pk_fma_f32 v[216:217], v[216:217], v[132:133], v[216:217]
    v_pk_fma_f32 v[220:221], v[220:221], v[132:133], v[224:225]
    v_pk_fma_f32 v[224:225], v[102:103], v[216:217], v[220:221]
    v_pk_fma_f32 v[216:217], v[216:217], v[134:135], v[216:217]
    v_pk_fma_f32 v[220:221], v[220:221], v[134:135], v[224:225]
    v_max3_f32 v6, v6, v216, v217
    v_mfma_f32_32x32x16_bf16 v[88:103], v[72:75], v[40:43], 0
    v_exp_f32 v120, v104
    v_exp_f32 v121, v105
    v_exp_f32 v122, v106
    v_mfma_f32_32x32x16_bf16 v[88:103], v[76:79], v[44:47], v[88:103]
    v_exp_f32 v123, v107
    v_exp_f32 v124, v108
    v_exp_f32 v125, v109
    v_mfma_f32_32x32x16_bf16 v[88:103], v[80:83], v[48:51], v[88:103]
    v_exp_f32 v126, v110
    v_exp_f32 v127, v111
    v_exp_f32 v128, v112
    v_mfma_f32_32x32x16_bf16 v[88:103], v[84:87], v[52:55], v[88:103]
    v_exp_f32 v129, v113
    v_exp_f32 v130, v114
    v_exp_f32 v131, v115
    v_mfma_f32_32x32x16_bf16 v[88:103], v[180:183], v[168:171], v[88:103]
    v_exp_f32 v132, v116
    v_exp_f32 v133, v117
    v_exp_f32 v134, v118
    v_exp_f32 v135, v119
    v_rcp_f32 v226, v216
    v_rcp_f32 v227, v217
    v_pk_add_f32 v[218:219], v[120:121], 1.0 op_sel_hi:[1,0]
    v_pk_fma_f32 v[224:225], v[106:107], v[218:219], v[104:105]
    v_pk_fma_f32 v[228:229], v[220:221], v[226:227], v[228:229]
    v_pk_fma_f32 v[218:219], v[218:219], v[122:123], v[218:219]
    s_waitcnt lgkmcnt(0)
    v_and_or_b32 v7, v176, s82, v4
    ds_read_b64 v[178:179], v7
    v_pk_fma_f32 v[222:223], v[104:105], v[122:123], v[224:225]
    v_pk_fma_f32 v[224:225], v[108:109], v[218:219], v[222:223]
    v_pk_fma_f32 v[218:219], v[218:219], v[124:125], v[218:219]
    ds_read_u16 v184, v190 offset:49664
    ds_read_u16 v186, v190 offset:49668
    v_pk_fma_f32 v[222:223], v[222:223], v[124:125], v[224:225]
    v_pk_fma_f32 v[224:225], v[110:111], v[218:219], v[222:223]
    v_pk_fma_f32 v[218:219], v[218:219], v[126:127], v[218:219]
    v_pk_fma_f32 v[222:223], v[222:223], v[126:127], v[224:225]
    ds_read_u16 v188, v190 offset:49672
    ds_read_u16 v190, v190 offset:49676
    v_pk_fma_f32 v[224:225], v[112:113], v[218:219], v[222:223]
    v_pk_fma_f32 v[218:219], v[218:219], v[128:129], v[218:219]
    v_pk_fma_f32 v[222:223], v[222:223], v[128:129], v[224:225]
    v_pk_fma_f32 v[224:225], v[114:115], v[218:219], v[222:223]
    v_pk_fma_f32 v[218:219], v[218:219], v[130:131], v[218:219]
    v_pk_fma_f32 v[222:223], v[222:223], v[130:131], v[224:225]
    v_pk_fma_f32 v[224:225], v[116:117], v[218:219], v[222:223]
    v_pk_fma_f32 v[218:219], v[218:219], v[132:133], v[218:219]
    v_pk_fma_f32 v[222:223], v[222:223], v[132:133], v[224:225]
    v_pk_fma_f32 v[224:225], v[118:119], v[218:219], v[222:223]
    v_pk_fma_f32 v[218:219], v[218:219], v[134:135], v[218:219]
    v_pk_fma_f32 v[222:223], v[222:223], v[134:135], v[224:225]
    v_max3_f32 v6, v6, v218, v219
    v_mfma_f32_32x32x16_bf16 v[104:119], v[72:75], v[56:59], 0
    v_exp_f32 v120, v88
    v_exp_f32 v121, v89
    v_exp_f32 v122, v90
    v_mfma_f32_32x32x16_bf16 v[104:119], v[76:79], v[60:63], v[104:119]
    v_exp_f32 v123, v91
    v_exp_f32 v124, v92
    v_exp_f32 v125, v93
    v_mfma_f32_32x32x16_bf16 v[104:119], v[80:83], v[64:67], v[104:119]
    v_exp_f32 v126, v94
    v_exp_f32 v127, v95
    v_exp_f32 v128, v96
    v_mfma_f32_32x32x16_bf16 v[104:119], v[84:87], v[68:71], v[104:119]
    v_exp_f32 v129, v97
    v_exp_f32 v130, v98
    v_exp_f32 v131, v99
    v_mfma_f32_32x32x16_bf16 v[104:119], v[180:183], v[172:175], v[104:119]
    v_exp_f32 v132, v100
    v_exp_f32 v133, v101
    v_exp_f32 v134, v102
    v_exp_f32 v135, v103
    v_rcp_f32 v226, v218
    v_rcp_f32 v227, v219
    s_waitcnt vmcnt(0)
    ds_read_b128 v[72:75], v192
    ds_read_b128 v[76:79], v193
    ds_read_b128 v[80:83], v194
    ds_read_b128 v[84:87], v195
    v_pk_add_f32 v[216:217], v[120:121], 1.0 op_sel_hi:[1,0]
    v_pk_fma_f32 v[224:225], v[90:91], v[216:217], v[88:89]
    v_pk_fma_f32 v[230:231], v[222:223], v[226:227], v[230:231]
    v_pk_fma_f32 v[216:217], v[216:217], v[122:123], v[216:217]
    s_bitcmp0_b32 s48, 1
    s_cbranch_scc1 K2_CF_b1_160
    v_add_u32_sdwa v212, v236, v2 dst_sel:DWORD dst_unused:UNUSED_PAD src0_sel:WORD_0 src1_sel:DWORD
    v_add_u32_sdwa v213, v237, v2 dst_sel:DWORD dst_unused:UNUSED_PAD src0_sel:WORD_0 src1_sel:DWORD
    ds_read_b32 v162, v212 offset:0
    ds_read_b32 v163, v213 offset:0
    ds_read_b32 v166, v212 offset:128
    ds_read_b32 v167, v213 offset:128
    ds_read_b32 v170, v212 offset:256
    ds_read_b32 v171, v213 offset:256
    ds_read_b32 v174, v212 offset:384
    ds_read_b32 v175, v213 offset:384
K2_CF_b1_160:
    v_pk_fma_f32 v[220:221], v[88:89], v[122:123], v[224:225]
    v_pk_fma_f32 v[224:225], v[92:93], v[216:217], v[220:221]
    v_pk_fma_f32 v[216:217], v[216:217], v[124:125], v[216:217]
    v_pk_fma_f32 v[220:221], v[220:221], v[124:125], v[224:225]
    v_pk_fma_f32 v[224:225], v[94:95], v[216:217], v[220:221]
    v_pk_fma_f32 v[216:217], v[216:217], v[126:127], v[216:217]
    v_pk_fma_f32 v[220:221], v[220:221], v[126:127], v[224:225]
    v_pk_fma_f32 v[224:225], v[96:97], v[216:217], v[220:221]
    v_pk_fma_f32 v[216:217], v[216:217], v[128:129], v[216:217]
    v_pk_fma_f32 v[220:221], v[220:221], v[128:129], v[224:225]
    v_pk_fma_f32 v[224:225], v[98:99], v[216:217], v[220:221]
    v_pk_fma_f32 v[216:217], v[216:217], v[130:131], v[216:217]
    v_pk_fma_f32 v[220:221], v[220:221], v[130:131], v[224:225]
    v_pk_fma_f32 v[224:225], v[100:101], v[216:217], v[220:221]
    v_pk_fma_f32 v[216:217], v[216:217], v[132:133], v[216:217]
    v_pk_fma_f32 v[220:221], v[220:221], v[132:133], v[224:225]
    v_pk_fma_f32 v[224:225], v[102:103], v[216:217], v[220:221]
    v_pk_fma_f32 v[216:217], v[216:217], v[134:135], v[216:217]
    v_pk_fma_f32 v[220:221], v[220:221], v[134:135], v[224:225]
    v_max3_f32 v6, v6, v216, v217
    s_setprio 0
    s_waitcnt lgkmcnt(0)
    s_waitcnt lgkmcnt(0)
    v_mfma_f32_32x32x16_bf16 v[88:103], v[72:75], v[8:11], 0
    v_exp_f32 v120, v104
    v_exp_f32 v121, v105
    v_exp_f32 v122, v106
    v_mfma_f32_32x32x16_bf16 v[88:103], v[76:79], v[12:15], v[88:103]
    v_exp_f32 v123, v107
    v_exp_f32 v124, v108
    v_exp_f32 v125, v109
    v_mfma_f32_32x32x16_bf16 v[88:103], v[80:83], v[16:19], v[88:103]
    v_exp_f32 v126, v110
    v_exp_f32 v127, v111
    v_exp_f32 v128, v112
    v_mfma_f32_32x32x16_bf16 v[88:103], v[84:87], v[20:23], v[88:103]
    v_exp_f32 v129, v113
    v_exp_f32 v130, v114
    v_exp_f32 v131, v115
    v_mfma_f32_32x32x16_bf16 v[88:103], v[176:179], v[160:163], v[88:103]
    v_exp_f32 v132, v116
    v_exp_f32 v133, v117
    v_exp_f32 v134, v118
    v_exp_f32 v135, v119
    v_rcp_f32 v226, v216
    v_rcp_f32 v227, v217
    v_pk_add_f32 v[218:219], v[120:121], 1.0 op_sel_hi:[1,0]
    v_pk_fma_f32 v[224:225], v[106:107], v[218:219], v[104:105]
    v_pk_fma_f32 v[232:233], v[220:221], v[226:227], v[232:233]
    s_mov_b32 m0, s36
    v_pk_fma_f32 v[218:219], v[218:219], v[122:123], v[218:219]
    buffer_load_dwordx4 v[184:185], s[12:15], 0 idxen offen lds
    v_pk_fma_f32 v[222:223], v[104:105], v[122:123], v[224:225]
    v_pk_fma_f32 v[224:225], v[108:109], v[218:219], v[222:223]
    v_pk_fma_f32 v[218:219], v[218:219], v[124:125], v[218:219]
    s_mov_b32 m0, s37
    v_pk_fma_f32 v[222:223], v[222:223], v[124:125], v[224:225]
    buffer_load_dwordx4 v[186:187], s[12:15], 0 idxen offen lds
    v_pk_fma_f32 v[224:225], v[110:111], v[218:219], v[222:223]
    v_pk_fma_f32 v[218:219], v[218:219], v[126:127], v[218:219]
    v_pk_fma_f32 v[222:223], v[222:223], v[126:127], v[224:225]
    s_mov_b32 m0, s38
    v_pk_fma_f32 v[224:225], v[112:113], v[218:219], v[222:223]
    buffer_load_dwordx4 v[188:189], s[12:15], 0 idxen offen lds
    v_pk_fma_f32 v[218:219], v[218:219], v[128:129], v[218:219]
    v_pk_fma_f32 v[222:223], v[222:223], v[128:129], v[224:225]
    v_pk_fma_f32 v[224:225], v[114:115], v[218:219], v[222:223]
    s_mov_b32 m0, s39
    v_pk_fma_f32 v[218:219], v[218:219], v[130:131], v[218:219]
    buffer_load_dwordx4 v[190:191], s[12:15], 0 idxen offen lds
    v_pk_fma_f32 v[222:223], v[222:223], v[130:131], v[224:225]
    v_pk_fma_f32 v[224:225], v[116:117], v[218:219], v[222:223]
    ds_read_u16 v180, v240 offset:6336
    v_pk_fma_f32 v[218:219], v[218:219], v[132:133], v[218:219]
    s_lshr_b64 s[48:49], s[48:49], 1
    v_pk_fma_f32 v[222:223], v[222:223], v[132:133], v[224:225]
    v_add_u32 v240, 0x80, v240
    v_add_u32 v241, 0x80, v241
    v_add_u32 v242, 0x80, v242
    v_pk_fma_f32 v[224:225], v[118:119], v[218:219], v[222:223]
    v_pk_fma_f32 v[218:219], v[218:219], v[134:135], v[218:219]
    v_pk_fma_f32 v[222:223], v[222:223], v[134:135], v[224:225]
    v_max3_f32 v6, v6, v218, v219
    s_sub_u32 s33, s33, 1
    s_cmp_lg_u32 s33, 0
    s_cbranch_scc1 K2_LOOPF
K2_DRF:
    v_rcp_f32 v226, v218
    v_rcp_f32 v227, v219
    s_nop 0
    v_pk_fma_f32 v[234:235], v[222:223], v[226:227], v[234:235]
    ds_write_b32 v214, v228 offset:0
    ds_write_b32 v215, v229 offset:0
    ds_write_b32 v214, v230 offset:128
    ds_write_b32 v215, v231 offset:128
    ds_write_b32 v214, v232 offset:256
    ds_write_b32 v215, v233 offset:256
    ds_write_b32 v214, v234 offset:384
    ds_write_b32 v215, v235 offset:384
K2_MAINDONE:
    s_setprio 0
    v_cmp_nge_f32 vcc, 0x53800000, v6
    v_mov_b32 v217, 768
    s_cbranch_vccz K2_NOG
    ds_write_b32 v217, v217 offset:4
K2_NOG:
    s_cmp_ge_u32 s24, 3
    s_cbranch_scc1 K2_NOW2
    s_mov_b32 s45, 0x1548800
    buffer_load_dwordx4 v[8:11], v5, s[16:19], s45 offen offset:0
    buffer_load_dwordx4 v[12:15], v5, s[16:19], s45 offen offset:1024
    buffer_load_dwordx4 v[16:19], v5, s[16:19], s45 offen offset:2048
    buffer_load_dwordx4 v[20:23], v5, s[16:19], s45 offen offset:3072
    s_mov_b32 s45, 0x1549800
    buffer_load_dwordx4 v[24:27], v5, s[16:19], s45 offen offset:0
    buffer_load_dwordx4 v[28:31], v5, s[16:19], s45 offen offset:1024
    buffer_load_dwordx4 v[32:35], v5, s[16:19], s45 offen offset:2048
    buffer_load_dwordx4 v[36:39], v5, s[16:19], s45 offen offset:3072
    s_mov_b32 s45, 0x154a800
    buffer_load_dwordx4 v[40:43], v5, s[16:19], s45 offen offset:0
    buffer_load_dwordx4 v[44:47], v5, s[16:19], s45 offen offset:1024
    buffer_load_dwordx4 v[48:51], v5, s[16:19], s45 offen offset:2048
    buffer_load_dwordx4 v[52:55], v5, s[16:19], s45 offen offset:3072
    s_mov_b32 s45, 0x154b800
    buffer_load_dwordx4 v[56:59], v5, s[16:19], s45 offen offset:0
    buffer_load_dwordx4 v[60:63], v5, s[16:19], s45 offen offset:1024
    buffer_load_dwordx4 v[64:67], v5, s[16:19], s45 offen offset:2048
    buffer_load_dwordx4 v[68:71], v5, s[16:19], s45 offen offset:3072
    v_lshrrev_b32 v218, 4, v1
    v_lshlrev_b32 v218, 4, v218
    s_lshl_b32 s40, s24, 4
    v_and_b32 v216, 15, v1
    v_add_u32 v216, s40, v216
    v_add_u32 v245, v245, v244
    v_add_u32 v247, -4, v244
    v_and_b32 v247, -32, v247
    v_add_u32 v247, v247, v246
    v_mul_u32_u24 v221, s31, v246
    v_lshrrev_b32 v221, 27, v221
    v_mad_i32_i24 v222, v221, s34, v246
    v_cmp_le_u32 vcc, s30, v222
    v_lshl_add_u32 v246, v221, 1, v216
    s_nop 0
    v_addc_co_u32 v246, vcc, 0, v246, vcc
    v_mul_u32_u24 v221, s31, v247
    v_lshrrev_b32 v221, 27, v221
    v_mad_i32_i24 v222, v221, s34, v247
    v_cmp_le_u32 vcc, s30, v222
    v_lshl_add_u32 v247, v221, 1, v216
    s_nop 0
    v_addc_co_u32 v247, vcc, 0, v247, vcc
    v_cmp_eq_u32 vcc, 0, v244
    s_movk_i32 s42, 528
    v_mov_b32 v223, 72
    v_cndmask_b32 v246, v246, v223, vcc
    v_cndmask_b32 v247, v247, v223, vcc
    v_lshlrev_b32 v221, 1, v218
    v_add_u32 v221, 0x14e00, v221
    v_mad_u32_u24 v246, v246, s42, v221
    v_mad_u32_u24 v247, v247, s42, v221
    v_add_u32 v244, 38016, v221
    v_add_u32 v222, 528, v246
    v_cmp_le_u32 vcc, v222, v247
    v_and_b32 v218, 48, v1
    v_add_u32 v218, 0x23d10, v218
    ds_read_b128 v[160:163], v218 offset:0
    ds_read_b128 v[164:167], v218 offset:64
    ds_read_b128 v[168:171], v218 offset:128
    ds_read_b128 v[172:175], v218 offset:192
    s_mov_b32 s43, 0xbf317218
    v_cndmask_b32 v219, v244, v222, vcc
    v_cvt_f32_u32 v218, v245
    v_mul_f32 v218, 0x3e800000, v218
    s_lshl_b32 s40, s24, 4
    v_and_b32 v216, 15, v1
    v_add_u32 v216, s40, v216
    v_cmp_gt_u32 s[80:81], s26, v216
    v_add_lshl_u32 v221, v216, s25, 7
    v_lshrrev_b32 v220, 4, v1
    v_lshl_add_u32 v221, v220, 3, v221
    s_waitcnt lgkmcnt(0)
    v_mul_f32 v160, v160, v218
    v_mul_f32 v161, v161, v218
    v_mul_f32 v162, v162, v218
    v_mul_f32 v163, v163, v218
    v_mul_f32 v164, v164, v218
    v_mul_f32 v165, v165, v218
    v_mul_f32 v166, v166, v218
    v_mul_f32 v167, v167, v218
    v_mul_f32 v168, v168, v218
    v_mul_f32 v169, v169, v218
    v_mul_f32 v170, v170, v218
    v_mul_f32 v171, v171, v218
    v_mul_f32 v172, v172, v218
    v_mul_f32 v173, v173, v218
    v_mul_f32 v174, v174, v218
    v_mul_f32 v175, v175, v218
K2_NOW2:
    s_cmp_ge_u32 s24, 3
    s_waitcnt vmcnt(0) lgkmcnt(0)
    s_barrier
    ds_read_b64 v[236:237], v217
    s_cbranch_scc1 K2_EPW
    ds_read_b128 v[88:91], v246 offset:0
    ds_read_b128 v[92:95], v246 offset:16
    ds_read_b128 v[96:99], v246 offset:128
    ds_read_b128 v[100:103], v246 offset:144
    ds_read_b128 v[104:107], v246 offset:256
    ds_read_b128 v[108:111], v246 offset:272
    ds_read_b128 v[112:115], v246 offset:384
    ds_read_b128 v[116:119], v246 offset:400
K2_FOLD:
    ds_read_b128 v[72:75], v219 offset:0
    ds_read_b128 v[76:79], v219 offset:16
    ds_read_b128 v[80:83], v219 offset:128
    ds_read_b128 v[84:87], v219 offset:144
    ds_read_b128 v[120:123], v219 offset:256
    ds_read_b128 v[124:127], v219 offset:272
    ds_read_b128 v[128:131], v219 offset:384
    ds_read_b128 v[132:135], v219 offset:400
    v_add_u32 v222, 528, v222
    v_cmp_le_u32 vcc, v222, v247
    s_waitcnt lgkmcnt(7)
    v_pk_add_f32 v[88:89], v[88:89], v[72:73]
    v_pk_add_f32 v[90:91], v[90:91], v[74:75]
    s_waitcnt lgkmcnt(6)
    v_pk_add_f32 v[92:93], v[92:93], v[76:77]
    v_pk_add_f32 v[94:95], v[94:95], v[78:79]
    s_waitcnt lgkmcnt(5)
    v_pk_add_f32 v[96:97], v[96:97], v[80:81]
    v_pk_add_f32 v[98:99], v[98:99], v[82:83]
    s_waitcnt lgkmcnt(4)
    v_pk_add_f32 v[100:101], v[100:101], v[84:85]
    v_pk_add_f32 v[102:103], v[102:103], v[86:87]
    s_waitcnt lgkmcnt(3)
    v_pk_add_f32 v[104:105], v[104:105], v[120:121]
    v_pk_add_f32 v[106:107], v[106:107], v[122:123]
    s_waitcnt lgkmcnt(2)
    v_pk_add_f32 v[108:109], v[108:109], v[124:125]
    v_pk_add_f32 v[110:111], v[110:111], v[126:127]
    s_waitcnt lgkmcnt(1)
    v_pk_add_f32 v[112:113], v[112:113], v[128:129]
    v_pk_add_f32 v[114:115], v[114:115], v[130:131]
    s_waitcnt lgkmcnt(0)
    v_pk_add_f32 v[116:117], v[116:117], v[132:133]
    v_pk_add_f32 v[118:119], v[118:119], v[134:135]
    v_cndmask_b32 v219, v244, v222, vcc
    s_cbranch_vccnz K2_FOLD
    v_cvt_pk_bf16_f32 v120, v88, v89
    v_cvt_pk_bf16_f32 v121, v90, v91
    v_cvt_pk_bf16_f32 v122, v92, v93
    v_cvt_pk_bf16_f32 v123, v94, v95
    s_nop 1
    v_mfma_f32_16x16x32_bf16 v[196:199], v[8:11], v[120:123], v[196:199]
    v_mfma_f32_16x16x32_bf16 v[200:203], v[24:27], v[120:123], v[200:203]
    v_mfma_f32_16x16x32_bf16 v[204:207], v[40:43], v[120:123], v[204:207]
    v_mfma_f32_16x16x32_bf16 v[208:211], v[56:59], v[120:123], v[208:211]
    v_cvt_pk_bf16_f32 v124, v96, v97
    v_cvt_pk_bf16_f32 v125, v98, v99
    v_cvt_pk_bf16_f32 v126, v100, v101
    v_cvt_pk_bf16_f32 v127, v102, v103
    s_nop 1
    v_mfma_f32_16x16x32_bf16 v[196:199], v[12:15], v[124:127], v[196:199]
    v_mfma_f32_16x16x32_bf16 v[200:203], v[28:31], v[124:127], v[200:203]
    v_mfma_f32_16x16x32_bf16 v[204:207], v[44:47], v[124:127], v[204:207]
    v_mfma_f32_16x16x32_bf16 v[208:211], v[60:63], v[124:127], v[208:211]
    v_cvt_pk_bf16_f32 v128, v104, v105
    v_cvt_pk_bf16_f32 v129, v106, v107
    v_cvt_pk_bf16_f32 v130, v108, v109
    v_cvt_pk_bf16_f32 v131, v110, v111
    s_nop 1
    v_mfma_f32_16x16x32_bf16 v[196:199], v[16:19], v[128:131], v[196:199]
    v_mfma_f32_16x16x32_bf16 v[200:203], v[32:35], v[128:131], v[200:203]
    v_mfma_f32_16x16x32_bf16 v[204:207], v[48:51], v[128:131], v[204:207]
    v_mfma_f32_16x16x32_bf16 v[208:211], v[64:67], v[128:131], v[208:211]
    v_cvt_pk_bf16_f32 v132, v112, v113
    v_cvt_pk_bf16_f32 v133, v114, v115
    v_cvt_pk_bf16_f32 v134, v116, v117
    v_cvt_pk_bf16_f32 v135, v118, v119
    s_nop 1
    v_mfma_f32_16x16x32_bf16 v[196:199], v[20:23], v[132:135], v[196:199]
    v_mfma_f32_16x16x32_bf16 v[200:203], v[36:39], v[132:135], v[200:203]
    v_mfma_f32_16x16x32_bf16 v[204:207], v[52:55], v[132:135], v[204:207]
    v_mfma_f32_16x16x32_bf16 v[208:211], v[68:71], v[132:135], v[208:211]
K2_EPW:
    s_waitcnt lgkmcnt(0)
    v_readfirstlane_b32 s84, v236
    v_readfirstlane_b32 s41, v237
    s_cmp_eq_u32 s41, 0
    s_cbranch_scc0 K2_GOSLOW
    s_cmp_ge_u32 s24, 3
    s_cbranch_scc1 K2_EPD
    s_cmp_lg_u32 s84, 0
    s_cbranch_scc1 K2_EPD
    s_mov_b64 exec, s[80:81]
    v_fma_f32 v88, v196, s43, v160
    v_fma_f32 v89, v197, s43, v161
    v_fma_f32 v90, v198, s43, v162
    v_fma_f32 v91, v199, s43, v163
    v_cvt_pk_bf16_f32 v104, v88, v89
    v_cvt_pk_bf16_f32 v105, v90, v91
    buffer_store_dwordx2 v[104:105], v221, s[20:23], 0 offen offset:0
    v_fma_f32 v92, v200, s43, v164
    v_fma_f32 v93, v201, s43, v165
    v_fma_f32 v94, v202, s43, v166
    v_fma_f32 v95, v203, s43, v167
    v_cvt_pk_bf16_f32 v106, v92, v93
    v_cvt_pk_bf16_f32 v107, v94, v95
    buffer_store_dwordx2 v[106:107], v221, s[20:23], 0 offen offset:32
    v_fma_f32 v96, v204, s43, v168
    v_fma_f32 v97, v205, s43, v169
    v_fma_f32 v98, v206, s43, v170
    v_fma_f32 v99, v207, s43, v171
    v_cvt_pk_bf16_f32 v108, v96, v97
    v_cvt_pk_bf16_f32 v109, v98, v99
    buffer_store_dwordx2 v[108:109], v221, s[20:23], 0 offen offset:64
    v_fma_f32 v100, v208, s43, v172
    v_fma_f32 v101, v209, s43, v173
    v_fma_f32 v102, v210, s43, v174
    v_fma_f32 v103, v211, s43, v175
    v_cvt_pk_bf16_f32 v110, v100, v101
    v_cvt_pk_bf16_f32 v111, v102, v103
    buffer_store_dwordx2 v[110:111], v221, s[20:23], 0 offen offset:96
    v_pk_add_f32 v[88:89], v[88:89], v[96:97]
    v_pk_add_f32 v[90:91], v[90:91], v[98:99]
    v_pk_add_f32 v[92:93], v[92:93], v[100:101]
    v_pk_add_f32 v[94:95], v[94:95], v[102:103]
    v_pk_add_f32 v[88:89], v[88:89], v[92:93]
    v_pk_add_f32 v[90:91], v[90:91], v[94:95]
    v_pk_add_f32 v[88:89], v[88:89], v[90:91]
    v_add_f32 v220, v88, v89
    v_mov_b32 v218, 0x207
    v_cmp_class_f32 vcc, v220, v218
    s_mov_b64 exec, -1
    s_cbranch_vccz K2_EPD
    ds_write_b32 v217, v217 offset:8
K2_EPD:
    s_waitcnt lgkmcnt(0)
    s_barrier
    s_cmp_lg_u32 s84, 0
    s_cbranch_scc1 K2_NEXT
    s_cmp_lg_u32 s28, 0
    s_cbranch_scc1 K2_END
    ds_read_b32 v218, v217 offset:8
    s_waitcnt lgkmcnt(0)
    v_readfirstlane_b32 s41, v218
    s_cmp_eq_u32 s41, 0
    s_cbranch_scc1 K2_END
K2_GOSLOW:
    s_waitcnt vmcnt(0)
    s_barrier
    s_mov_b32 s28, 1
    s_mov_b32 s27, 0
    s_branch K2_RESTART
K2_NEXT:
    s_add_u32 s27, s27, 1
    s_branch K2_ROUND
K2_END:
    s_endpgm
K2_RL1:
    v_lshlrev_b32 v217, 10, v216
    s_lshl_b32 s40, s3, 2
    s_add_u32 s40, s40, 0x1500000
    buffer_load_dword v228, v217, s[16:19], s40 offen
    s_add_u32 s41, s40, 0x10000
    buffer_load_dword v229, v217, s[16:19], s41 offen
    s_add_u32 s42, s41, 0x10000
    buffer_load_dword v230, v217, s[16:19], s42 offen
    s_add_u32 s43, s42, 0x10000
    buffer_load_dword v231, v217, s[16:19], s43 offen
    s_branch K2_RL2
K2_BL:
    s_lshl_b32 s40, s3, 14
    s_add_u32 s40, s40, 0xd00000
    v_lshlrev_b32 v218, 3, v0
    buffer_load_dwordx2 v[94:95], v218, s[16:19], s40 offen
    s_add_u32 s40, s40, 0x1000
    buffer_load_dwordx2 v[102:103], v218, s[16:19], s40 offen
    s_add_u32 s40, s40, 0x1000
    buffer_load_dwordx2 v[110:111], v218, s[16:19], s40 offen
    s_add_u32 s40, s40, 0x1000
    buffer_load_dwordx2 v[118:119], v218, s[16:19], s40 offen
    s_add_u32 s40, s40, 0x1000
    s_branch K2_RL3
K2_RM1:
    s_mov_b32 s40, 0x800000
    s_waitcnt vmcnt(0)
    v_lshrrev_b32 v218, 16, v228
    v_cmp_lt_u32 vcc, 32, v212
    v_and_b32 v228, s83, v228
    s_nop 0
    v_cndmask_b32 v212, v212, v218, vcc
    v_lshl_add_u32 v228, v228, 3, v247
    buffer_load_dword v88, v228, s[16:19], s40 offen offset:0
    buffer_load_dword v92, v228, s[16:19], s40 offen offset:4
    buffer_load_dword v89, v228, s[16:19], s40 offen offset:64
    buffer_load_dword v93, v228, s[16:19], s40 offen offset:68
    buffer_load_dword v90, v228, s[16:19], s40 offen offset:128
    buffer_load_dword v91, v228, s[16:19], s40 offen offset:132
    buffer_load_dword v94, v228, s[16:19], s40 offen offset:192
    buffer_load_dword v95, v228, s[16:19], s40 offen offset:196
    s_add_u32 s40, s40, 0x138800
    v_lshrrev_b32 v218, 16, v229
    v_cmp_lt_u32 vcc, 32, v213
    v_and_b32 v229, s83, v229
    s_nop 0
    v_cndmask_b32 v213, v213, v218, vcc
    v_lshl_add_u32 v229, v229, 3, v247
    buffer_load_dword v96, v229, s[16:19], s40 offen offset:0
    buffer_load_dword v100, v229, s[16:19], s40 offen offset:4
    buffer_load_dword v97, v229, s[16:19], s40 offen offset:64
    buffer_load_dword v101, v229, s[16:19], s40 offen offset:68
    buffer_load_dword v98, v229, s[16:19], s40 offen offset:128
    buffer_load_dword v99, v229, s[16:19], s40 offen offset:132
    buffer_load_dword v102, v229, s[16:19], s40 offen offset:192
    buffer_load_dword v103, v229, s[16:19], s40 offen offset:196
    s_add_u32 s40, s40, 0x138800
    v_lshrrev_b32 v218, 16, v230
    v_cmp_lt_u32 vcc, 32, v214
    v_and_b32 v230, s83, v230
    s_nop 0
    v_cndmask_b32 v214, v214, v218, vcc
    v_lshl_add_u32 v230, v230, 3, v247
    buffer_load_dword v104, v230, s[16:19], s40 offen offset:0
    buffer_load_dword v108, v230, s[16:19], s40 offen offset:4
    buffer_load_dword v105, v230, s[16:19], s40 offen offset:64
    buffer_load_dword v109, v230, s[16:19], s40 offen offset:68
    buffer_load_dword v106, v230, s[16:19], s40 offen offset:128
    buffer_load_dword v107, v230, s[16:19], s40 offen offset:132
    buffer_load_dword v110, v230, s[16:19], s40 offen offset:192
    buffer_load_dword v111, v230, s[16:19], s40 offen offset:196
    s_add_u32 s40, s40, 0x138800
    v_lshrrev_b32 v218, 16, v231
    v_cmp_lt_u32 vcc, 32, v215
    v_and_b32 v231, s83, v231
    s_nop 0
    v_cndmask_b32 v215, v215, v218, vcc
    v_lshl_add_u32 v231, v231, 3, v247
    buffer_load_dword v112, v231, s[16:19], s40 offen offset:0
    buffer_load_dword v116, v231, s[16:19], s40 offen offset:4
    buffer_load_dword v113, v231, s[16:19], s40 offen offset:64
    buffer_load_dword v117, v231, s[16:19], s40 offen offset:68
    buffer_load_dword v114, v231, s[16:19], s40 offen offset:128
    buffer_load_dword v115, v231, s[16:19], s40 offen offset:132
    buffer_load_dword v118, v231, s[16:19], s40 offen offset:192
    buffer_load_dword v119, v231, s[16:19], s40 offen offset:196
    s_add_u32 s40, s40, 0x138800
    s_waitcnt vmcnt(0)
    v_sub_u32 v218, v212, v246
    v_cmp_lt_i32 s[48:49], 0, v218
    v_cmp_lt_i32 s[50:51], 8, v218
    v_cmp_lt_i32 s[52:53], 16, v218
    v_cmp_lt_i32 s[54:55], 24, v218
    s_mov_b64 exec, s[48:49]
    ds_add_rtn_u32 v136, v92, v217 offset:512
    s_mov_b64 exec, s[50:51]
    ds_add_rtn_u32 v137, v93, v217 offset:512
    s_mov_b64 exec, -1
    v_sub_u32 v218, v213, v246
    v_cmp_lt_i32 s[56:57], 0, v218
    v_cmp_lt_i32 s[58:59], 8, v218
    v_cmp_lt_i32 s[60:61], 16, v218
    v_cmp_lt_i32 s[62:63], 24, v218
    s_mov_b64 exec, s[56:57]
    ds_add_rtn_u32 v140, v100, v217 offset:512
    s_mov_b64 exec, s[58:59]
    ds_add_rtn_u32 v141, v101, v217 offset:512
    s_mov_b64 exec, -1
    v_sub_u32 v218, v214, v246
    v_cmp_lt_i32 s[64:65], 0, v218
    v_cmp_lt_i32 s[66:67], 8, v218
    v_cmp_lt_i32 s[68:69], 16, v218
    v_cmp_lt_i32 s[70:71], 24, v218
    s_mov_b64 exec, s[64:65]
    ds_add_rtn_u32 v144, v108, v217 offset:512
    s_mov_b64 exec, s[66:67]
    ds_add_rtn_u32 v145, v109, v217 offset:512
    s_mov_b64 exec, -1
    v_sub_u32 v218, v215, v246
    v_cmp_lt_i32 s[72:73], 0, v218
    v_cmp_lt_i32 s[74:75], 8, v218
    v_cmp_lt_i32 s[76:77], 16, v218
    v_cmp_lt_i32 s[78:79], 24, v218
    s_mov_b64 exec, s[72:73]
    ds_add_rtn_u32 v148, v116, v217 offset:512
    s_mov_b64 exec, s[74:75]
    ds_add_rtn_u32 v149, v117, v217 offset:512
    s_mov_b64 exec, -1
    s_branch K2_RM2
K2_P1B0:
    s_waitcnt vmcnt(1)
    s_mov_b64 exec, s[54:55]
    ds_add_rtn_u32 v139, v95, v217 offset:512
    s_branch K2_P1S0
K2_P1B1:
    s_waitcnt vmcnt(1)
    s_mov_b64 exec, s[62:63]
    ds_add_rtn_u32 v143, v103, v217 offset:512
    s_branch K2_P1S1
K2_P1B2:
    s_waitcnt vmcnt(1)
    s_mov_b64 exec, s[70:71]
    ds_add_rtn_u32 v147, v111, v217 offset:512
    s_branch K2_P1S2
K2_P1B3:
    s_waitcnt vmcnt(1)
    s_mov_b64 exec, s[78:79]
    ds_add_rtn_u32 v151, v119, v217 offset:512
    s_branch K2_P1S3
K2_OVF:
    v_sub_u32 v243, v243, v223
    ds_write_b32 v222, v243 offset:14336
    v_mov_b32 v124, s82
    v_mov_b32 v125, s82
    v_mov_b32 v126, s82
    v_mov_b32 v127, s82
    v_lshlrev_b32 v221, 4, v0
    v_add_u32 v221, 0xc200, v221
    ds_write_b128 v221, v[124:127] offset:0
    ds_write_b128 v221, v[124:127] offset:8192
    ds_write_b128 v221, v[124:127] offset:16384
    ds_write_b128 v221, v[124:127] offset:24576
    s_cmp_ge_u32 s24, 3
    s_cbranch_scc1 K2_OV1
    ds_write_b128 v221, v[124:127] offset:32768
K2_OV1:
    s_waitcnt lgkmcnt(0)
    s_barrier
    v_add_u32 v217, v219, v227
    s_mov_b64 exec, s[48:49]
    ds_read_b32 v92, v92 offset:14336
    s_waitcnt lgkmcnt(0)
    v_add_u32 v92, v92, v136
    ds_write_b32 v92, v88 offset:49664
    s_mov_b64 exec, s[50:51]
    ds_read_b32 v93, v93 offset:14336
    s_waitcnt lgkmcnt(0)
    v_add_u32 v93, v93, v137
    ds_write_b32 v93, v89 offset:49664
    s_mov_b64 exec, s[52:53]
    ds_read_b32 v91, v91 offset:14336
    s_waitcnt lgkmcnt(0)
    v_add_u32 v91, v91, v138
    ds_write_b32 v91, v90 offset:49664
    s_mov_b64 exec, s[54:55]
    ds_read_b32 v95, v95 offset:14336
    s_waitcnt lgkmcnt(0)
    v_add_u32 v95, v95, v139
    ds_write_b32 v95, v94 offset:49664
    s_mov_b64 exec, s[56:57]
    ds_read_b32 v100, v100 offset:14336
    s_waitcnt lgkmcnt(0)
    v_add_u32 v100, v100, v140
    ds_write_b32 v100, v96 offset:49664
    s_mov_b64 exec, s[58:59]
    ds_read_b32 v101, v101 offset:14336
    s_waitcnt lgkmcnt(0)
    v_add_u32 v101, v101, v141
    ds_write_b32 v101, v97 offset:49664
    s_mov_b64 exec, s[60:61]
    ds_read_b32 v99, v99 offset:14336
    s_waitcnt lgkmcnt(0)
    v_add_u32 v99, v99, v142
    ds_write_b32 v99, v98 offset:49664
    s_mov_b64 exec, s[62:63]
    ds_read_b32 v103, v103 offset:14336
    s_waitcnt lgkmcnt(0)
    v_add_u32 v103, v103, v143
    ds_write_b32 v103, v102 offset:49664
    s_mov_b64 exec, s[64:65]
    ds_read_b32 v108, v108 offset:14336
    s_waitcnt lgkmcnt(0)
    v_add_u32 v108, v108, v144
    ds_write_b32 v108, v104 offset:49664
    s_mov_b64 exec, s[66:67]
    ds_read_b32 v109, v109 offset:14336
    s_waitcnt lgkmcnt(0)
    v_add_u32 v109, v109, v145
    ds_write_b32 v109, v105 offset:49664
    s_mov_b64 exec, s[68:69]
    ds_read_b32 v107, v107 offset:14336
    s_waitcnt lgkmcnt(0)
    v_add_u32 v107, v107, v146
    ds_write_b32 v107, v106 offset:49664
    s_mov_b64 exec, s[70:71]
    ds_read_b32 v111, v111 offset:14336
    s_waitcnt lgkmcnt(0)
    v_add_u32 v111, v111, v147
    ds_write_b32 v111, v110 offset:49664
    s_mov_b64 exec, s[72:73]
    ds_read_b32 v116, v116 offset:14336
    s_waitcnt lgkmcnt(0)
    v_add_u32 v116, v116, v148
    ds_write_b32 v116, v112 offset:49664
    s_mov_b64 exec, s[74:75]
    ds_read_b32 v117, v117 offset:14336
    s_waitcnt lgkmcnt(0)
    v_add_u32 v117, v117, v149
    ds_write_b32 v117, v113 offset:49664
    s_mov_b64 exec, s[76:77]
    ds_read_b32 v115, v115 offset:14336
    s_waitcnt lgkmcnt(0)
    v_add_u32 v115, v115, v150
    ds_write_b32 v115, v114 offset:49664
    s_mov_b64 exec, s[78:79]
    ds_read_b32 v119, v119 offset:14336
    s_waitcnt lgkmcnt(0)
    v_add_u32 v119, v119, v151
    ds_write_b32 v119, v118 offset:49664
    s_mov_b64 exec, -1
    s_branch K2_NOOVF
K2_LOOPS:
    s_setprio 1
    v_mfma_f32_32x32x16_bf16 v[104:119], v[72:75], v[24:27], 0
    v_exp_f32 v120, v88
    v_exp_f32 v121, v89
    v_exp_f32 v122, v90
    v_mfma_f32_32x32x16_bf16 v[104:119], v[76:79], v[28:31], v[104:119]
    v_exp_f32 v123, v91
    v_exp_f32 v124, v92
    v_exp_f32 v125, v93
    v_mfma_f32_32x32x16_bf16 v[104:119], v[80:83], v[32:35], v[104:119]
    v_exp_f32 v126, v94
    v_exp_f32 v127, v95
    v_exp_f32 v128, v96
    v_mfma_f32_32x32x16_bf16 v[104:119], v[84:87], v[36:39], v[104:119]
    v_exp_f32 v129, v97
    v_exp_f32 v130, v98
    v_exp_f32 v131, v99
    v_mfma_f32_32x32x16_bf16 v[104:119], v[176:179], v[164:167], v[104:119]
    v_exp_f32 v132, v100
    v_exp_f32 v133, v101
    v_exp_f32 v134, v102
    v_exp_f32 v135, v103
    v_pk_add_f32 v[120:121], v[120:121], 1.0 op_sel_hi:[1,0]
    v_pk_add_f32 v[122:123], v[122:123], 1.0 op_sel_hi:[1,0]
    v_pk_add_f32 v[234:235], v[222:223], v[234:235]
    v_pk_add_f32 v[124:125], v[124:125], 1.0 op_sel_hi:[1,0]
    s_bitcmp0_b32 s48, 0
    s_cbranch_scc1 K2_CS_b0_26
    v_cmp_eq_u32 s[52:53], v236, v238
    v_cmp_eq_u32 s[54:55], v237, v239
    ds_write_b32 v214, v228 offset:0
    ds_write_b32 v215, v229 offset:0
    ds_write_b32 v214, v230 offset:128
    ds_write_b32 v215, v231 offset:128
    ds_write_b32 v214, v232 offset:256
    ds_write_b32 v215, v233 offset:256
    ds_write_b32 v214, v234 offset:384
    ds_write_b32 v215, v235 offset:384
    v_add_u32_sdwa v214, v236, v3 dst_sel:DWORD dst_unused:UNUSED_PAD src0_sel:WORD_1 src1_sel:DWORD
    v_add_u32_sdwa v215, v237, v3 dst_sel:DWORD dst_unused:UNUSED_PAD src0_sel:WORD_1 src1_sel:DWORD
    v_cndmask_b32 v228, 0, v228, s[52:53]
    v_cndmask_b32 v229, 0, v229, s[54:55]
    v_cndmask_b32 v230, 0, v230, s[52:53]
    v_cndmask_b32 v231, 0, v231, s[54:55]
    v_cndmask_b32 v232, 0, v232, s[52:53]
    v_cndmask_b32 v233, 0, v233, s[54:55]
    v_cndmask_b32 v234, 0, v234, s[52:53]
    v_cndmask_b32 v235, 0, v235, s[54:55]
K2_CS_b0_26:
    ds_read_b64 v[238:239], v242 offset:1088
    v_pk_add_f32 v[126:127], v[126:127], 1.0 op_sel_hi:[1,0]
    v_pk_add_f32 v[128:129], v[128:129], 1.0 op_sel_hi:[1,0]
    v_pk_add_f32 v[130:131], v[130:131], 1.0 op_sel_hi:[1,0]
    v_pk_add_f32 v[132:133], v[132:133], 1.0 op_sel_hi:[1,0]
    v_pk_add_f32 v[134:135], v[134:135], 1.0 op_sel_hi:[1,0]
    ds_read_u16 v190, v241 offset:6272
    v_rcp_f32 v120, v120
    v_rcp_f32 v121, v121
    v_rcp_f32 v122, v122
    v_rcp_f32 v123, v123
    s_waitcnt lgkmcnt(2)
    v_add_u32 v180, v180, v249
    ds_read_b32 v180, v180 offset:49664
    v_rcp_f32 v124, v124
    v_rcp_f32 v125, v125
    v_rcp_f32 v126, v126
    v_rcp_f32 v127, v127
    v_rcp_f32 v128, v128
    v_rcp_f32 v129, v129
    v_rcp_f32 v130, v130
    v_rcp_f32 v131, v131
    v_rcp_f32 v132, v132
    v_rcp_f32 v133, v133
    v_rcp_f32 v134, v134
    v_rcp_f32 v135, v135
    v_pk_mul_f32 v[220:221], v[88:89], v[120:121]
    v_pk_fma_f32 v[220:221], v[90:91], v[122:123], v[220:221]
    v_pk_fma_f32 v[220:221], v[92:93], v[124:125], v[220:221]
    v_pk_fma_f32 v[220:221], v[94:95], v[126:127], v[220:221]
    v_pk_fma_f32 v[220:221], v[96:97], v[128:129], v[220:221]
    v_pk_fma_f32 v[220:221], v[98:99], v[130:131], v[220:221]
    v_pk_fma_f32 v[220:221], v[100:101], v[132:133], v[220:221]
    v_pk_fma_f32 v[220:221], v[102:103], v[134:135], v[220:221]
    v_mfma_f32_32x32x16_bf16 v[88:103], v[72:75], v[40:43], 0
    v_exp_f32 v120, v104
    v_exp_f32 v121, v105
    v_exp_f32 v122, v106
    v_mfma_f32_32x32x16_bf16 v[88:103], v[76:79], v[44:47], v[88:103]
    v_exp_f32 v123, v107
    v_exp_f32 v124, v108
    v_exp_f32 v125, v109
    v_mfma_f32_32x32x16_bf16 v[88:103], v[80:83], v[48:51], v[88:103]
    v_exp_f32 v126, v110
    v_exp_f32 v127, v111
    v_exp_f32 v128, v112
    v_mfma_f32_32x32x16_bf16 v[88:103], v[84:87], v[52:55], v[88:103]
    v_exp_f32 v129, v113
    v_exp_f32 v130, v114
    v_exp_f32 v131, v115
    v_mfma_f32_32x32x16_bf16 v[88:103], v[176:179], v[168:171], v[88:103]
    v_exp_f32 v132, v116
    v_exp_f32 v133, v117
    v_exp_f32 v134, v118
    v_exp_f32 v135, v119
    v_pk_add_f32 v[120:121], v[120:121], 1.0 op_sel_hi:[1,0]
    v_pk_add_f32 v[122:123], v[122:123], 1.0 op_sel_hi:[1,0]
    v_pk_add_f32 v[228:229], v[220:221], v[228:229]
    v_pk_add_f32 v[124:125], v[124:125], 1.0 op_sel_hi:[1,0]
    s_waitcnt lgkmcnt(0)
    v_and_or_b32 v7, v180, s82, v4
    ds_read_b64 v[182:183], v7
    v_pk_add_f32 v[126:127], v[126:127], 1.0 op_sel_hi:[1,0]
    v_pk_add_f32 v[128:129], v[128:129], 1.0 op_sel_hi:[1,0]
    v_pk_add_f32 v[130:131], v[130:131], 1.0 op_sel_hi:[1,0]
    ds_read_u16 v184, v190 offset:49664
    ds_read_u16 v186, v190 offset:49668
    v_pk_add_f32 v[132:133], v[132:133], 1.0 op_sel_hi:[1,0]
    v_pk_add_f32 v[134:135], v[134:135], 1.0 op_sel_hi:[1,0]
    v_rcp_f32 v120, v120
    v_rcp_f32 v121, v121
    ds_read_u16 v188, v190 offset:49672
    ds_read_u16 v190, v190 offset:49676
    v_rcp_f32 v122, v122
    v_rcp_f32 v123, v123
    v_rcp_f32 v124, v124
    v_rcp_f32 v125, v125
    v_rcp_f32 v126, v126
    v_rcp_f32 v127, v127
    v_rcp_f32 v128, v128
    v_rcp_f32 v129, v129
    v_rcp_f32 v130, v130
    v_rcp_f32 v131, v131
    v_rcp_f32 v132, v132
    v_rcp_f32 v133, v133
    v_rcp_f32 v134, v134
    v_rcp_f32 v135, v135
    v_pk_mul_f32 v[222:223], v[104:105], v[120:121]
    v_pk_fma_f32 v[222:223], v[106:107], v[122:123], v[222:223]
    v_pk_fma_f32 v[222:223], v[108:109], v[124:125], v[222:223]
    v_pk_fma_f32 v[222:223], v[110:111], v[126:127], v[222:223]
    v_pk_fma_f32 v[222:223], v[112:113], v[128:129], v[222:223]
    v_pk_fma_f32 v[222:223], v[114:115], v[130:131], v[222:223]
    v_pk_fma_f32 v[222:223], v[116:117], v[132:133], v[222:223]
    v_pk_fma_f32 v[222:223], v[118:119], v[134:135], v[222:223]
    v_mfma_f32_32x32x16_bf16 v[104:119], v[72:75], v[56:59], 0
    v_exp_f32 v120, v88
    v_exp_f32 v121, v89
    v_exp_f32 v122, v90
    v_mfma_f32_32x32x16_bf16 v[104:119], v[76:79], v[60:63], v[104:119]
    v_exp_f32 v123, v91
    v_exp_f32 v124, v92
    v_exp_f32 v125, v93
    v_mfma_f32_32x32x16_bf16 v[104:119], v[80:83], v[64:67], v[104:119]
    v_exp_f32 v126, v94
    v_exp_f32 v127, v95
    v_exp_f32 v128, v96
    v_mfma_f32_32x32x16_bf16 v[104:119], v[84:87], v[68:71], v[104:119]
    v_exp_f32 v129, v97
    v_exp_f32 v130, v98
    v_exp_f32 v131, v99
    v_mfma_f32_32x32x16_bf16 v[104:119], v[176:179], v[172:175], v[104:119]
    v_exp_f32 v132, v100
    v_exp_f32 v133, v101
    v_exp_f32 v134, v102
    v_exp_f32 v135, v103
    s_waitcnt vmcnt(0)
    ds_read_b128 v[72:75], v192
    ds_read_b128 v[76:79], v193
    ds_read_b128 v[80:83], v194
    ds_read_b128 v[84:87], v195
    v_pk_add_f32 v[120:121], v[120:121], 1.0 op_sel_hi:[1,0]
    v_pk_add_f32 v[122:123], v[122:123], 1.0 op_sel_hi:[1,0]
    v_pk_add_f32 v[230:231], v[222:223], v[230:231]
    v_pk_add_f32 v[124:125], v[124:125], 1.0 op_sel_hi:[1,0]
    s_bitcmp0_b32 s48, 1
    s_cbranch_scc1 K2_CS_b0_174
    v_add_u32_sdwa v212, v238, v2 dst_sel:DWORD dst_unused:UNUSED_PAD src0_sel:WORD_0 src1_sel:DWORD
    v_add_u32_sdwa v213, v239, v2 dst_sel:DWORD dst_unused:UNUSED_PAD src0_sel:WORD_0 src1_sel:DWORD
    ds_read_b32 v162, v212 offset:0
    ds_read_b32 v163, v213 offset:0
    ds_read_b32 v166, v212 offset:128
    ds_read_b32 v167, v213 offset:128
    ds_read_b32 v170, v212 offset:256
    ds_read_b32 v171, v213 offset:256
    ds_read_b32 v174, v212 offset:384
    ds_read_b32 v175, v213 offset:384
K2_CS_b0_174:
    v_pk_add_f32 v[126:127], v[126:127], 1.0 op_sel_hi:[1,0]
    v_pk_add_f32 v[128:129], v[128:129], 1.0 op_sel_hi:[1,0]
    v_pk_add_f32 v[130:131], v[130:131], 1.0 op_sel_hi:[1,0]
    v_pk_add_f32 v[132:133], v[132:133], 1.0 op_sel_hi:[1,0]
    v_pk_add_f32 v[134:135], v[134:135], 1.0 op_sel_hi:[1,0]
    v_rcp_f32 v120, v120
    v_rcp_f32 v121, v121
    v_rcp_f32 v122, v122
    v_rcp_f32 v123, v123
    v_rcp_f32 v124, v124
    v_rcp_f32 v125, v125
    v_rcp_f32 v126, v126
    v_rcp_f32 v127, v127
    v_rcp_f32 v128, v128
    v_rcp_f32 v129, v129
    v_rcp_f32 v130, v130
    v_rcp_f32 v131, v131
    v_rcp_f32 v132, v132
    v_rcp_f32 v133, v133
    v_rcp_f32 v134, v134
    v_rcp_f32 v135, v135
    v_pk_mul_f32 v[220:221], v[88:89], v[120:121]
    v_pk_fma_f32 v[220:221], v[90:91], v[122:123], v[220:221]
    v_pk_fma_f32 v[220:221], v[92:93], v[124:125], v[220:221]
    v_pk_fma_f32 v[220:221], v[94:95], v[126:127], v[220:221]
    v_pk_fma_f32 v[220:221], v[96:97], v[128:129], v[220:221]
    v_pk_fma_f32 v[220:221], v[98:99], v[130:131], v[220:221]
    v_pk_fma_f32 v[220:221], v[100:101], v[132:133], v[220:221]
    v_pk_fma_f32 v[220:221], v[102:103], v[134:135], v[220:221]
    s_setprio 0
    s_waitcnt lgkmcnt(0)
    s_waitcnt lgkmcnt(0)
    v_mfma_f32_32x32x16_bf16 v[88:103], v[72:75], v[8:11], 0
    v_exp_f32 v120, v104
    v_exp_f32 v121, v105
    v_exp_f32 v122, v106
    v_mfma_f32_32x32x16_bf16 v[88:103], v[76:79], v[12:15], v[88:103]
    v_exp_f32 v123, v107
    v_exp_f32 v124, v108
    v_exp_f32 v125, v109
    v_mfma_f32_32x32x16_bf16 v[88:103], v[80:83], v[16:19], v[88:103]
    v_exp_f32 v126, v110
    v_exp_f32 v127, v111
    v_exp_f32 v128, v112
    v_mfma_f32_32x32x16_bf16 v[88:103], v[84:87], v[20:23], v[88:103]
    v_exp_f32 v129, v113
    v_exp_f32 v130, v114
    v_exp_f32 v131, v115
    v_mfma_f32_32x32x16_bf16 v[88:103], v[180:183], v[160:163], v[88:103]
    v_exp_f32 v132, v116
    v_exp_f32 v133, v117
    v_exp_f32 v134, v118
    v_exp_f32 v135, v119
    v_pk_add_f32 v[120:121], v[120:121], 1.0 op_sel_hi:[1,0]
    v_pk_add_f32 v[122:123], v[122:123], 1.0 op_sel_hi:[1,0]
    v_pk_add_f32 v[232:233], v[220:221], v[232:233]
    s_mov_b32 m0, s36
    v_pk_add_f32 v[124:125], v[124:125], 1.0 op_sel_hi:[1,0]
    buffer_load_dwordx4 v[184:185], s[12:15], 0 idxen offen lds
    v_pk_add_f32 v[126:127], v[126:127], 1.0 op_sel_hi:[1,0]
    v_pk_add_f32 v[128:129], v[128:129], 1.0 op_sel_hi:[1,0]
    v_pk_add_f32 v[130:131], v[130:131], 1.0 op_sel_hi:[1,0]
    s_mov_b32 m0, s37
    v_pk_add_f32 v[132:133], v[132:133], 1.0 op_sel_hi:[1,0]
    buffer_load_dwordx4 v[186:187], s[12:15], 0 idxen offen lds
    v_pk_add_f32 v[134:135], v[134:135], 1.0 op_sel_hi:[1,0]
    v_rcp_f32 v120, v120
    v_rcp_f32 v121, v121
    s_mov_b32 m0, s38
    v_rcp_f32 v122, v122
    buffer_load_dwordx4 v[188:189], s[12:15], 0 idxen offen lds
    v_rcp_f32 v123, v123
    v_rcp_f32 v124, v124
    v_rcp_f32 v125, v125
    s_mov_b32 m0, s39
    v_rcp_f32 v126, v126
    buffer_load_dwordx4 v[190:191], s[12:15], 0 idxen offen lds
    v_rcp_f32 v127, v127
    v_rcp_f32 v128, v128
    ds_read_u16 v176, v240 offset:6272
    v_rcp_f32 v129, v129
    s_lshr_b64 s[48:49], s[48:49], 1
    v_rcp_f32 v130, v130
    v_rcp_f32 v131, v131
    v_rcp_f32 v132, v132
    v_rcp_f32 v133, v133
    v_rcp_f32 v134, v134
    v_rcp_f32 v135, v135
    v_pk_mul_f32 v[222:223], v[104:105], v[120:121]
    v_pk_fma_f32 v[222:223], v[106:107], v[122:123], v[222:223]
    v_pk_fma_f32 v[222:223], v[108:109], v[124:125], v[222:223]
    v_pk_fma_f32 v[222:223], v[110:111], v[126:127], v[222:223]
    v_pk_fma_f32 v[222:223], v[112:113], v[128:129], v[222:223]
    v_pk_fma_f32 v[222:223], v[114:115], v[130:131], v[222:223]
    v_pk_fma_f32 v[222:223], v[116:117], v[132:133], v[222:223]
    v_pk_fma_f32 v[222:223], v[118:119], v[134:135], v[222:223]
    s_sub_u32 s33, s33, 1
    s_cmp_eq_u32 s33, 0
    s_cbranch_scc1 K2_DRS
    s_setprio 1
    v_mfma_f32_32x32x16_bf16 v[104:119], v[72:75], v[24:27], 0
    v_exp_f32 v120, v88
    v_exp_f32 v121, v89
    v_exp_f32 v122, v90
    v_mfma_f32_32x32x16_bf16 v[104:119], v[76:79], v[28:31], v[104:119]
    v_exp_f32 v123, v91
    v_exp_f32 v124, v92
    v_exp_f32 v125, v93
    v_mfma_f32_32x32x16_bf16 v[104:119], v[80:83], v[32:35], v[104:119]
    v_exp_f32 v126, v94
    v_exp_f32 v127, v95
    v_exp_f32 v128, v96
    v_mfma_f32_32x32x16_bf16 v[104:119], v[84:87], v[36:39], v[104:119]
    v_exp_f32 v129, v97
    v_exp_f32 v130, v98
    v_exp_f32 v131, v99
    v_mfma_f32_32x32x16_bf16 v[104:119], v[180:183], v[164:167], v[104:119]
    v_exp_f32 v132, v100
    v_exp_f32 v133, v101
    v_exp_f32 v134, v102
    v_exp_f32 v135, v103
    v_pk_add_f32 v[120:121], v[120:121], 1.0 op_sel_hi:[1,0]
    v_pk_add_f32 v[122:123], v[122:123], 1.0 op_sel_hi:[1,0]
    v_pk_add_f32 v[234:235], v[222:223], v[234:235]
    v_pk_add_f32 v[124:125], v[124:125], 1.0 op_sel_hi:[1,0]
    s_bitcmp0_b32 s48, 0
    s_cbranch_scc1 K2_CS_b1_26
    v_cmp_eq_u32 s[52:53], v236, v238
    v_cmp_eq_u32 s[54:55], v237, v239
    ds_write_b32 v214, v228 offset:0
    ds_write_b32 v215, v229 offset:0
    ds_write_b32 v214, v230 offset:128
    ds_write_b32 v215, v231 offset:128
    ds_write_b32 v214, v232 offset:256
    ds_write_b32 v215, v233 offset:256
    ds_write_b32 v214, v234 offset:384
    ds_write_b32 v215, v235 offset:384
    v_add_u32_sdwa v214, v238, v3 dst_sel:DWORD dst_unused:UNUSED_PAD src0_sel:WORD_1 src1_sel:DWORD
    v_add_u32_sdwa v215, v239, v3 dst_sel:DWORD dst_unused:UNUSED_PAD src0_sel:WORD_1 src1_sel:DWORD
    v_cndmask_b32 v228, 0, v228, s[52:53]
    v_cndmask_b32 v229, 0, v229, s[54:55]
    v_cndmask_b32 v230, 0, v230, s[52:53]
    v_cndmask_b32 v231, 0, v231, s[54:55]
    v_cndmask_b32 v232, 0, v232, s[52:53]
    v_cndmask_b32 v233, 0, v233, s[54:55]
    v_cndmask_b32 v234, 0, v234, s[52:53]
    v_cndmask_b32 v235, 0, v235, s[54:55]
K2_CS_b1_26:
    ds_read_b64 v[236:237], v242 offset:1152
    v_pk_add_f32 v[126:127], v[126:127], 1.0 op_sel_hi:[1,0]
    v_pk_add_f32 v[128:129], v[128:129], 1.0 op_sel_hi:[1,0]
    v_pk_add_f32 v[130:131], v[130:131], 1.0 op_sel_hi:[1,0]
    v_pk_add_f32 v[132:133], v[132:133], 1.0 op_sel_hi:[1,0]
    v_pk_add_f32 v[134:135], v[134:135], 1.0 op_sel_hi:[1,0]
    ds_read_u16 v190, v241 offset:6336
    v_rcp_f32 v120, v120
    v_rcp_f32 v121, v121
    v_rcp_f32 v122, v122
    v_rcp_f32 v123, v123
    s_waitcnt lgkmcnt(2)
    v_add_u32 v176, v176, v249
    ds_read_b32 v176, v176 offset:49664
    v_rcp_f32 v124, v124
    v_rcp_f32 v125, v125
    v_rcp_f32 v126, v126
    v_rcp_f32 v127, v127
    v_rcp_f32 v128, v128
    v_rcp_f32 v129, v129
    v_rcp_f32 v130, v130
    v_rcp_f32 v131, v131
    v_rcp_f32 v132, v132
    v_rcp_f32 v133, v133
    v_rcp_f32 v134, v134
    v_rcp_f32 v135, v135
    v_pk_mul_f32 v[220:221], v[88:89], v[120:121]
    v_pk_fma_f32 v[220:221], v[90:91], v[122:123], v[220:221]
    v_pk_fma_f32 v[220:221], v[92:93], v[124:125], v[220:221]
    v_pk_fma_f32 v[220:221], v[94:95], v[126:127], v[220:221]
    v_pk_fma_f32 v[220:221], v[96:97], v[128:129], v[220:221]
    v_pk_fma_f32 v[220:221], v[98:99], v[130:131], v[220:221]
    v_pk_fma_f32 v[220:221], v[100:101], v[132:133], v[220:221]
    v_pk_fma_f32 v[220:221], v[102:103], v[134:135], v[220:221]
    v_mfma_f32_32x32x16_bf16 v[88:103], v[72:75], v[40:43], 0
    v_exp_f32 v120, v104
    v_exp_f32 v121, v105
    v_exp_f32 v122, v106
    v_mfma_f32_32x32x16_bf16 v[88:103], v[76:79], v[44:47], v[88:103]
    v_exp_f32 v123, v107
    v_exp_f32 v124, v108
    v_exp_f32 v125, v109
    v_mfma_f32_32x32x16_bf16 v[88:103], v[80:83], v[48:51], v[88:103]
    v_exp_f32 v126, v110
    v_exp_f32 v127, v111
    v_exp_f32 v128, v112
    v_mfma_f32_32x32x16_bf16 v[88:103], v[84:87], v[52:55], v[88:103]
    v_exp_f32 v129, v113
    v_exp_f32 v130, v114
    v_exp_f32 v131, v115
    v_mfma_f32_32x32x16_bf16 v[88:103], v[180:183], v[168:171], v[88:103]
    v_exp_f32 v132, v116
    v_exp_f32 v133, v117
    v_exp_f32 v134, v118
    v_exp_f32 v135, v119
    v_pk_add_f32 v[120:121], v[120:121], 1.0 op_sel_hi:[1,0]
    v_pk_add_f32 v[122:123], v[122:123], 1.0 op_sel_hi:[1,0]
    v_pk_add_f32 v[228:229], v[220:221], v[228:229]
    v_pk_add_f32 v[124:125], v[124:125], 1.0 op_sel_hi:[1,0]
    s_waitcnt lgkmcnt(0)
    v_and_or_b32 v7, v176, s82, v4
    ds_read_b64 v[178:179], v7
    v_pk_add_f32 v[126:127], v[126:127], 1.0 op_sel_hi:[1,0]
    v_pk_add_f32 v[128:129], v[128:129], 1.0 op_sel_hi:[1,0]
    v_pk_add_f32 v[130:131], v[130:131], 1.0 op_sel_hi:[1,0]
    ds_read_u16 v184, v190 offset:49664
    ds_read_u16 v186, v190 offset:49668
    v_pk_add_f32 v[132:133], v[132:133], 1.0 op_sel_hi:[1,0]
    v_pk_add_f32 v[134:135], v[134:135], 1.0 op_sel_hi:[1,0]
    v_rcp_f32 v120, v120
    v_rcp_f32 v121, v121
    ds_read_u16 v188, v190 offset:49672
    ds_read_u16 v190, v190 offset:49676
    v_rcp_f32 v122, v122
    v_rcp_f32 v123, v123
    v_rcp_f32 v124, v124
    v_rcp_f32 v125, v125
    v_rcp_f32 v126, v126
    v_rcp_f32 v127, v127
    v_rcp_f32 v128, v128
    v_rcp_f32 v129, v129
    v_rcp_f32 v130, v130
    v_rcp_f32 v131, v131
    v_rcp_f32 v132, v132
    v_rcp_f32 v133, v133
    v_rcp_f32 v134, v134
    v_rcp_f32 v135, v135
    v_pk_mul_f32 v[222:223], v[104:105], v[120:121]
    v_pk_fma_f32 v[222:223], v[106:107], v[122:123], v[222:223]
    v_pk_fma_f32 v[222:223], v[108:109], v[124:125], v[222:223]
    v_pk_fma_f32 v[222:223], v[110:111], v[126:127], v[222:223]
    v_pk_fma_f32 v[222:223], v[112:113], v[128:129], v[222:223]
    v_pk_fma_f32 v[222:223], v[114:115], v[130:131], v[222:223]
    v_pk_fma_f32 v[222:223], v[116:117], v[132:133], v[222:223]
    v_pk_fma_f32 v[222:223], v[118:119], v[134:135], v[222:223]
    v_mfma_f32_32x32x16_bf16 v[104:119], v[72:75], v[56:59], 0
    v_exp_f32 v120, v88
    v_exp_f32 v121, v89
    v_exp_f32 v122, v90
    v_mfma_f32_32x32x16_bf16 v[104:119], v[76:79], v[60:63], v[104:119]
    v_exp_f32 v123, v91
    v_exp_f32 v124, v92
    v_exp_f32 v125, v93
    v_mfma_f32_32x32x16_bf16 v[104:119], v[80:83], v[64:67], v[104:119]
    v_exp_f32 v126, v94
    v_exp_f32 v127, v95
    v_exp_f32 v128, v96
    v_mfma_f32_32x32x16_bf16 v[104:119], v[84:87], v[68:71], v[104:119]
    v_exp_f32 v129, v97
    v_exp_f32 v130, v98
    v_exp_f32 v131, v99
    v_mfma_f32_32x32x16_bf16 v[104:119], v[180:183], v[172:175], v[104:119]
    v_exp_f32 v132, v100
    v_exp_f32 v133, v101
    v_exp_f32 v134, v102
    v_exp_f32 v135, v103
    s_waitcnt vmcnt(0)
    ds_read_b128 v[72:75], v192
    ds_read_b128 v[76:79], v193
    ds_read_b128 v[80:83], v194
    ds_read_b128 v[84:87], v195
    v_pk_add_f32 v[120:121], v[120:121], 1.0 op_sel_hi:[1,0]
    v_pk_add_f32 v[122:123], v[122:123], 1.0 op_sel_hi:[1,0]
    v_pk_add_f32 v[230:231], v[222:223], v[230:231]
    v_pk_add_f32 v[124:125], v[124:125], 1.0 op_sel_hi:[1,0]
    s_bitcmp0_b32 s48, 1
    s_cbranch_scc1 K2_CS_b1_174
    v_add_u32_sdwa v212, v236, v2 dst_sel:DWORD dst_unused:UNUSED_PAD src0_sel:WORD_0 src1_sel:DWORD
    v_add_u32_sdwa v213, v237, v2 dst_sel:DWORD dst_unused:UNUSED_PAD src0_sel:WORD_0 src1_sel:DWORD
    ds_read_b32 v162, v212 offset:0
    ds_read_b32 v163, v213 offset:0
    ds_read_b32 v166, v212 offset:128
    ds_read_b32 v167, v213 offset:128
    ds_read_b32 v170, v212 offset:256
    ds_read_b32 v171, v213 offset:256
    ds_read_b32 v174, v212 offset:384
    ds_read_b32 v175, v213 offset:384
K2_CS_b1_174:
    v_pk_add_f32 v[126:127], v[126:127], 1.0 op_sel_hi:[1,0]
    v_pk_add_f32 v[128:129], v[128:129], 1.0 op_sel_hi:[1,0]
    v_pk_add_f32 v[130:131], v[130:131], 1.0 op_sel_hi:[1,0]
    v_pk_add_f32 v[132:133], v[132:133], 1.0 op_sel_hi:[1,0]
    v_pk_add_f32 v[134:135], v[134:135], 1.0 op_sel_hi:[1,0]
    v_rcp_f32 v120, v120
    v_rcp_f32 v121, v121
    v_rcp_f32 v122, v122
    v_rcp_f32 v123, v123
    v_rcp_f32 v124, v124
    v_rcp_f32 v125, v125
    v_rcp_f32 v126, v126
    v_rcp_f32 v127, v127
    v_rcp_f32 v128, v128
    v_rcp_f32 v129, v129
    v_rcp_f32 v130, v130
    v_rcp_f32 v131, v131
    v_rcp_f32 v132, v132
    v_rcp_f32 v133, v133
    v_rcp_f32 v134, v134
    v_rcp_f32 v135, v135
    v_pk_mul_f32 v[220:221], v[88:89], v[120:121]
    v_pk_fma_f32 v[220:221], v[90:91], v[122:123], v[220:221]
    v_pk_fma_f32 v[220:221], v[92:93], v[124:125], v[220:221]
    v_pk_fma_f32 v[220:221], v[94:95], v[126:127], v[220:221]
    v_pk_fma_f32 v[220:221], v[96:97], v[128:129], v[220:221]
    v_pk_fma_f32 v[220:221], v[98:99], v[130:131], v[220:221]
    v_pk_fma_f32 v[220:221], v[100:101], v[132:133], v[220:221]
    v_pk_fma_f32 v[220:221], v[102:103], v[134:135], v[220:221]
    s_setprio 0
    s_waitcnt lgkmcnt(0)
    s_waitcnt lgkmcnt(0)
    v_mfma_f32_32x32x16_bf16 v[88:103], v[72:75], v[8:11], 0
    v_exp_f32 v120, v104
    v_exp_f32 v121, v105
    v_exp_f32 v122, v106
    v_mfma_f32_32x32x16_bf16 v[88:103], v[76:79], v[12:15], v[88:103]
    v_exp_f32 v123, v107
    v_exp_f32 v124, v108
    v_exp_f32 v125, v109
    v_mfma_f32_32x32x16_bf16 v[88:103], v[80:83], v[16:19], v[88:103]
    v_exp_f32 v126, v110
    v_exp_f32 v127, v111
    v_exp_f32 v128, v112
    v_mfma_f32_32x32x16_bf16 v[88:103], v[84:87], v[20:23], v[88:103]
    v_exp_f32 v129, v113
    v_exp_f32 v130, v114
    v_exp_f32 v131, v115
    v_mfma_f32_32x32x16_bf16 v[88:103], v[176:179], v[160:163], v[88:103]
    v_exp_f32 v132, v116
    v_exp_f32 v133, v117
    v_exp_f32 v134, v118
    v_exp_f32 v135, v119
    v_pk_add_f32 v[120:121], v[120:121], 1.0 op_sel_hi:[1,0]
    v_pk_add_f32 v[122:123], v[122:123], 1.0 op_sel_hi:[1,0]
    v_pk_add_f32 v[232:233], v[220:221], v[232:233]
    s_mov_b32 m0, s36
    v_pk_add_f32 v[124:125], v[124:125], 1.0 op_sel_hi:[1,0]
    buffer_load_dwordx4 v[184:185], s[12:15], 0 idxen offen lds
    v_pk_add_f32 v[126:127], v[126:127], 1.0 op_sel_hi:[1,0]
    v_pk_add_f32 v[128:129], v[128:129], 1.0 op_sel_hi:[1,0]
    v_pk_add_f32 v[130:131], v[130:131], 1.0 op_sel_hi:[1,0]
    s_mov_b32 m0, s37
    v_pk_add_f32 v[132:133], v[132:133], 1.0 op_sel_hi:[1,0]
    buffer_load_dwordx4 v[186:187], s[12:15], 0 idxen offen lds
    v_pk_add_f32 v[134:135], v[134:135], 1.0 op_sel_hi:[1,0]
    v_rcp_f32 v120, v120
    v_rcp_f32 v121, v121
    s_mov_b32 m0, s38
    v_rcp_f32 v122, v122
    buffer_load_dwordx4 v[188:189], s[12:15], 0 idxen offen lds
    v_rcp_f32 v123, v123
    v_rcp_f32 v124, v124
    v_rcp_f32 v125, v125
    s_mov_b32 m0, s39
    v_rcp_f32 v126, v126
    buffer_load_dwordx4 v[190:191], s[12:15], 0 idxen offen lds
    v_rcp_f32 v127, v127
    v_rcp_f32 v128, v128
    ds_read_u16 v180, v240 offset:6336
    v_rcp_f32 v129, v129
    s_lshr_b64 s[48:49], s[48:49], 1
    v_rcp_f32 v130, v130
    v_add_u32 v240, 0x80, v240
    v_add_u32 v241, 0x80, v241
    v_add_u32 v242, 0x80, v242
    v_rcp_f32 v131, v131
    v_rcp_f32 v132, v132
    v_rcp_f32 v133, v133
    v_rcp_f32 v134, v134
    v_rcp_f32 v135, v135
    v_pk_mul_f32 v[222:223], v[104:105], v[120:121]
    v_pk_fma_f32 v[222:223], v[106:107], v[122:123], v[222:223]
    v_pk_fma_f32 v[222:223], v[108:109], v[124:125], v[222:223]
    v_pk_fma_f32 v[222:223], v[110:111], v[126:127], v[222:223]
    v_pk_fma_f32 v[222:223], v[112:113], v[128:129], v[222:223]
    v_pk_fma_f32 v[222:223], v[114:115], v[130:131], v[222:223]
    v_pk_fma_f32 v[222:223], v[116:117], v[132:133], v[222:223]
    v_pk_fma_f32 v[222:223], v[118:119], v[134:135], v[222:223]
    s_sub_u32 s33, s33, 1
    s_cmp_lg_u32 s33, 0
    s_cbranch_scc1 K2_LOOPS
K2_DRS:
    v_pk_add_f32 v[234:235], v[222:223], v[234:235]
    ds_write_b32 v214, v228 offset:0
    ds_write_b32 v215, v229 offset:0
    ds_write_b32 v214, v230 offset:128
    ds_write_b32 v215, v231 offset:128
    ds_write_b32 v214, v232 offset:256
    ds_write_b32 v215, v233 offset:256
    ds_write_b32 v214, v234 offset:384
    ds_write_b32 v215, v235 offset:384
    s_branch K2_MAINDONE
.section .rodata,"a"
.p2align 6
.amdhsa_kernel mpnn_bin_kernel
  .amdhsa_next_free_vgpr 72
  .amdhsa_next_free_sgpr 56
  .amdhsa_accum_offset 72
  .amdhsa_group_segment_fixed_size 0
  .amdhsa_kernarg_size 88
  .amdhsa_user_sgpr_count 2
  .amdhsa_user_sgpr_kernarg_segment_ptr 1
  .amdhsa_system_sgpr_workgroup_id_x 1
.end_amdhsa_kernel
.p2align 6
.amdhsa_kernel mpnn_main_kernel
  .amdhsa_next_free_vgpr 256
  .amdhsa_next_free_sgpr 102
  .amdhsa_accum_offset 256
  .amdhsa_group_segment_fixed_size 0
  .amdhsa_kernarg_size 88
  .amdhsa_user_sgpr_count 2
  .amdhsa_user_sgpr_kernarg_segment_ptr 1
  .amdhsa_system_sgpr_workgroup_id_x 1
.end_amdhsa_kernel
```
